```python
import torch

def _softmax(x, axis=-1):
    return torch.softmax(x, dim=axis)
def _gelu(x):
    return torch.nn.functional.gelu(x, approximate="tanh")
def _silu(x):
    return torch.nn.functional.silu(x)
def _sigmoid(x):
    return torch.sigmoid(x)
def _layernorm(x, axis=-1, eps=1e-5):
    m = x.mean(dim=axis, keepdim=True)
    v = x.var(dim=axis, keepdim=True, unbiased=False)
    return (x - m) / torch.sqrt(v + eps)
def _scatter_add(tgt, idx, src, axis=0):
    return tgt.clone().index_add_(axis, idx, src)
def _segment_sum(src, seg, n):
    out = torch.zeros((n,) + src.shape[1:], dtype=src.dtype)
    return out.index_add_(0, seg, src)
def _pad(x, pw):
    flat = tuple(v for pair in reversed(pw) for v in pair)
    return torch.nn.functional.pad(x, flat)

kernel_name = 'concat_heads__mha_block_cached__gqa_block_cached__decode'

def setup_inputs():

    _w = (lambda a: (lambda t: t.to(torch.bfloat16) if t.is_floating_point() else t)(torch.as_tensor(a)))
    def _A_setup():
        B, Sq, D = 1, 1, 576
        H, Sk, Dh = 32, 65536, 128
        return {
            "x": _w((lambda *s: torch.randn(*s, dtype=torch.bfloat16) * 0.8)(B, Sq, D)),
            "k_cache": _w((lambda *s: torch.randn(*s, dtype=torch.bfloat16) * 1.6)(B, H, Sk, Dh)),
            "v_cache": _w((lambda *s: torch.randn(*s, dtype=torch.bfloat16) * 0.2)(B, H, Sk, Dh)),
            "wq": _w((lambda *s: torch.randn(*s, dtype=torch.bfloat16) * 1.6)(D, H * Dh) * (D ** -0.5)),
            "wo": _w((lambda *s: torch.randn(*s, dtype=torch.bfloat16) * 0.2)(H * Dh, D) * ((H * Dh) ** -0.5)),
        }
    _A_in = _A_setup()

    def _B_setup():
        B, Sq, D = 1, 1, 576
        Hq, Hkv, Sk, Dh = 32, 16, 65536, 128
        assert Hq % Hkv == 0, (Hq, Hkv)
        return {
            "x": _w((lambda *s: torch.randn(*s, dtype=torch.bfloat16) * 0.8)(B, Sq, D)),
            "k_cache": _w((lambda *s: torch.randn(*s, dtype=torch.bfloat16) * 1.6)(B, Hkv, Sk, Dh)),
            "v_cache": _w((lambda *s: torch.randn(*s, dtype=torch.bfloat16) * 0.2)(B, Hkv, Sk, Dh)),
            "wq": _w((lambda *s: torch.randn(*s, dtype=torch.bfloat16) * 1.6)(D, Hq * Dh) * (D ** -0.5)),
            "wo": _w((lambda *s: torch.randn(*s, dtype=torch.bfloat16) * 0.2)(Hq * Dh, D) * ((Hq * Dh) ** -0.5)),
        }
    _B_in = _B_setup()

    return {
        "A_x": _A_in["x"],
        "A_k_cache": _A_in["k_cache"],
        "A_v_cache": _A_in["v_cache"],
        "A_wq": _A_in["wq"],
        "A_wo": _A_in["wo"],
        "B_x": _B_in["x"],
        "B_k_cache": _B_in["k_cache"],
        "B_v_cache": _B_in["v_cache"],
        "B_wq": _B_in["wq"],
        "B_wo": _B_in["wo"],
    }

def reference(A_x, A_k_cache, A_v_cache, A_wq, A_wo, B_x, B_k_cache, B_v_cache, B_wq, B_wo):
    def _A_ref(x, k_cache, v_cache, wq, wo):
        B, Sq, D = x.shape
        H, Dh = 32, 128
        q = (lambda x, *d: x.permute(*d))((x @ wq).reshape(B, Sq, H, Dh), 0, 2, 1, 3)
        scores = torch.einsum("bhqd,bhkd->bhqk", q, k_cache) * (Dh ** -0.5)
        p = _softmax(scores, axis=-1)
        o = torch.einsum("bhqk,bhkd->bhqd", p, v_cache)
        return (lambda x, *d: x.permute(*d))(o, 0, 2, 1, 3).reshape(B, Sq, H * Dh) @ wo

    def _B_ref(x, k_cache, v_cache, wq, wo):
        B, Sq, D = x.shape
        Hq, Dh = 32, 128
        Hkv = k_cache.shape[1]
        rep = Hq // Hkv
        q = (lambda x, *d: x.permute(*d))((x @ wq).reshape(B, Sq, Hq, Dh), 0, 2, 1, 3)
        k = (lambda x, n, axis: torch.repeat_interleave(x, n, dim=axis))(k_cache, rep, axis=1)
        v = (lambda x, n, axis: torch.repeat_interleave(x, n, dim=axis))(v_cache, rep, axis=1)
        scores = torch.einsum("bhqd,bhkd->bhqk", q, k) * (Dh ** -0.5)
        p = _softmax(scores, axis=-1)
        o = torch.einsum("bhqk,bhkd->bhqd", p, v)
        return (lambda x, *d: x.permute(*d))(o, 0, 2, 1, 3).reshape(B, Sq, Hq * Dh) @ wo

    a = _A_ref(A_x, A_k_cache, A_v_cache, A_wq, A_wo)
    b = _B_ref(B_x, B_k_cache, B_v_cache, B_wq, B_wo)
    return torch.concatenate([a, b], axis=-1)
```

```asm
; @launch grid=(256,1,1) block=(320,1,1) lds=59648
.amdgcn_target "amdgcn-amd-amdhsa--gfx950"
.text
.globl concat_heads__mha_block_cached__gqa_block_cached__decode_kernel
.p2align 8
.type concat_heads__mha_block_cached__gqa_block_cached__decode_kernel,@function
concat_heads__mha_block_cached__gqa_block_cached__decode_kernel:
s_cmp_ge_u32 s2, 256
s_cbranch_scc1 L_end_1
s_load_dwordx16 s[4:19], s[0:1], 0
s_load_dwordx8 s[20:27], s[0:1], 64
s_load_dwordx2 s[28:29], s[0:1], 96
v_lshrrev_b32 v1, 6, v0
v_mov_b32 v3, v0
v_and_b32 v0, 63, v0
v_readfirstlane_b32 s30, v1
s_mov_b32 s3, s2
s_lshr_b32 s31, s2, 4
s_and_b32 s64, s2, 15
s_mov_b32 s43, 0x20000
s_mov_b32 s42, 4521984
s_mov_b64 s[82:83], -1
s_cmp_eq_u32 s30, 4
s_cbranch_scc1 L_svc_2
v_lshrrev_b32 v4, 2, v3
v_and_b32 v5, 3, v3
v_lshlrev_b32 v5, 4, v5
v_lshl_add_u32 v5, v4, 13, v5
v_lshlrev_b32 v4, 1, v4
s_and_b32 s65, s64, 3
s_lshl_b32 s65, s65, 7
s_lshr_b32 s66, s64, 3
s_lshl_b32 s66, s66, 6
s_add_u32 s65, s65, s66
s_lshl_b32 s66, s31, 9
s_add_u32 s65, s65, s66
s_mov_b32 s46, 4718592
s_mov_b32 s47, s43
s_mov_b32 s50, 1152
s_mov_b32 s51, s43
s_mov_b32 s34, 0x1000000
s_mov_b32 s35, s43
s_mov_b32 s38, s34
s_mov_b32 s39, s43
s_mov_b32 s76, 32768
s_lshl_b32 s60, s64, 20
s_lshl_b32 s61, s30, 12
s_add_u32 s60, s60, s61
s_mov_b32 s61, s60
s_lshl_b32 s62, s31, 24
v_lshrrev_b32 v2, 4, v0
v_lshlrev_b32 v250, 4, v2
v_bfe_u32 v2, v0, 2, 2
v_lshl_add_u32 v250, v2, 8, v250
v_and_b32 v2, 3, v0
v_lshl_add_u32 v1, v2, 10, v250
v_and_b32 v2, 1, v0
v_lshl_add_u32 v250, v2, 6, v250
v_bfe_u32 v2, v0, 1, 1
v_lshl_add_u32 v250, v2, 10, v250
v_lshlrev_b32 v2, 4, v0
v_mov_b32 v228, v250
v_add_u32 v229, 128, v250
v_add_u32 v230, 2048, v250
v_add_u32 v231, 2176, v250
v_add_u32 v232, 16384, v250
v_add_u32 v233, 16512, v250
v_add_u32 v234, 18432, v250
v_add_u32 v235, 18560, v250
s_and_b32 s66, s64, 4
s_cmp_eq_u32 s66, 0
s_waitcnt lgkmcnt(0)
s_cselect_b32 s44, s20, s10
s_cselect_b32 s45, s21, s11
s_cselect_b32 s48, s14, s4
s_cselect_b32 s49, s15, s5
s_add_u32 s32, s16, s62
s_addc_u32 s33, s17, 0
s_mov_b32 s36, s32
s_mov_b32 s37, s33
buffer_load_dwordx4 v[56:59], v5, s[44:47], s65 offen nt
s_add_u32 s65, s65, 524288
buffer_load_dwordx4 v[60:63], v5, s[44:47], s65 offen nt
s_add_u32 s65, s65, 524288
buffer_load_dwordx4 v[64:67], v5, s[44:47], s65 offen nt
s_add_u32 s65, s65, 524288
buffer_load_dwordx4 v[68:71], v5, s[44:47], s65 offen nt
s_add_u32 s65, s65, 524288
buffer_load_dwordx4 v[72:75], v5, s[44:47], s65 offen nt
s_add_u32 s65, s65, 524288
buffer_load_dwordx4 v[76:79], v5, s[44:47], s65 offen nt
s_add_u32 s65, s65, 524288
buffer_load_dwordx4 v[80:83], v5, s[44:47], s65 offen nt
s_add_u32 s65, s65, 524288
buffer_load_dwordx4 v[84:87], v5, s[44:47], s65 offen nt
s_add_u32 s65, s65, 524288
buffer_load_dwordx4 v[88:91], v5, s[44:47], s65 offen nt
buffer_load_ushort v40, v4, s[48:51], 0 offen offset:0
buffer_load_ushort v41, v4, s[48:51], 0 offen offset:128
buffer_load_ushort v42, v4, s[48:51], 0 offen offset:256
buffer_load_ushort v43, v4, s[48:51], 0 offen offset:384
buffer_load_ushort v44, v4, s[48:51], 0 offen offset:512
buffer_load_ushort v45, v4, s[48:51], 0 offen offset:640
buffer_load_ushort v46, v4, s[48:51], 0 offen offset:768
buffer_load_ushort v47, v4, s[48:51], 0 offen offset:896
buffer_load_ushort v48, v4, s[48:51], 0 offen offset:1024
buffer_load_dwordx4 v[96:99], v228, s[32:35], s61 offen nt
buffer_load_dwordx4 v[100:103], v229, s[32:35], s61 offen nt
buffer_load_dwordx4 v[104:107], v230, s[32:35], s61 offen nt
buffer_load_dwordx4 v[108:111], v231, s[32:35], s61 offen nt
s_mov_b32 s40, s28
s_mov_b32 s41, s29
s_add_u32 s74, s28, 3407872
s_addc_u32 s75, s29, 0
s_load_dword s73, s[74:75], 0
s_add_u32 s98, s18, s62
s_addc_u32 s99, s19, 0
s_lshl_b32 s62, s62, 1
s_add_u32 s52, s6, s62
s_addc_u32 s53, s7, 0
s_add_u32 s54, s8, s62
s_addc_u32 s55, s9, 0
s_add_u32 s56, s52, s34
s_addc_u32 s57, s53, 0
s_add_u32 s58, s54, s34
s_addc_u32 s59, s55, 0
L_qc_3:
s_mov_b32 s66, 0xffff0000
s_waitcnt vmcnt(12)
v_lshlrev_b32 v40, 16, v40
v_lshlrev_b32 v20, 16, v56
v_and_b32 v21, s66, v56
v_mul_f32 v24, v40, v20
v_mul_f32 v25, v40, v21
v_lshlrev_b32 v20, 16, v57
v_and_b32 v21, s66, v57
v_mul_f32 v26, v40, v20
v_mul_f32 v27, v40, v21
v_lshlrev_b32 v20, 16, v58
v_and_b32 v21, s66, v58
v_mul_f32 v28, v40, v20
v_mul_f32 v29, v40, v21
v_lshlrev_b32 v20, 16, v59
v_and_b32 v21, s66, v59
v_mul_f32 v30, v40, v20
v_mul_f32 v31, v40, v21
s_waitcnt vmcnt(11)
v_lshlrev_b32 v41, 16, v41
v_lshlrev_b32 v20, 16, v60
v_and_b32 v21, s66, v60
v_fmac_f32 v24, v41, v20
v_fmac_f32 v25, v41, v21
v_lshlrev_b32 v20, 16, v61
v_and_b32 v21, s66, v61
v_fmac_f32 v26, v41, v20
v_fmac_f32 v27, v41, v21
v_lshlrev_b32 v20, 16, v62
v_and_b32 v21, s66, v62
v_fmac_f32 v28, v41, v20
v_fmac_f32 v29, v41, v21
v_lshlrev_b32 v20, 16, v63
v_and_b32 v21, s66, v63
v_fmac_f32 v30, v41, v20
v_fmac_f32 v31, v41, v21
s_waitcnt vmcnt(10)
v_lshlrev_b32 v42, 16, v42
v_lshlrev_b32 v20, 16, v64
v_and_b32 v21, s66, v64
v_fmac_f32 v24, v42, v20
v_fmac_f32 v25, v42, v21
v_lshlrev_b32 v20, 16, v65
v_and_b32 v21, s66, v65
v_fmac_f32 v26, v42, v20
v_fmac_f32 v27, v42, v21
v_lshlrev_b32 v20, 16, v66
v_and_b32 v21, s66, v66
v_fmac_f32 v28, v42, v20
v_fmac_f32 v29, v42, v21
v_lshlrev_b32 v20, 16, v67
v_and_b32 v21, s66, v67
v_fmac_f32 v30, v42, v20
v_fmac_f32 v31, v42, v21
s_waitcnt vmcnt(9)
v_lshlrev_b32 v43, 16, v43
v_lshlrev_b32 v20, 16, v68
v_and_b32 v21, s66, v68
v_fmac_f32 v24, v43, v20
v_fmac_f32 v25, v43, v21
v_lshlrev_b32 v20, 16, v69
v_and_b32 v21, s66, v69
v_fmac_f32 v26, v43, v20
v_fmac_f32 v27, v43, v21
v_lshlrev_b32 v20, 16, v70
v_and_b32 v21, s66, v70
v_fmac_f32 v28, v43, v20
v_fmac_f32 v29, v43, v21
v_lshlrev_b32 v20, 16, v71
v_and_b32 v21, s66, v71
v_fmac_f32 v30, v43, v20
v_fmac_f32 v31, v43, v21
s_waitcnt vmcnt(8)
s_cbranch_execz L_skip_5
buffer_load_dwordx4 v[112:115], v232, s[36:39], s61 offen nt
buffer_load_dwordx4 v[116:119], v233, s[36:39], s61 offen nt
buffer_load_dwordx4 v[120:123], v234, s[36:39], s61 offen nt
buffer_load_dwordx4 v[124:127], v235, s[36:39], s61 offen nt
L_skip_5:
s_add_u32 s61, s61, s76
v_lshlrev_b32 v44, 16, v44
v_lshlrev_b32 v20, 16, v72
v_and_b32 v21, s66, v72
v_fmac_f32 v24, v44, v20
v_fmac_f32 v25, v44, v21
v_lshlrev_b32 v20, 16, v73
v_and_b32 v21, s66, v73
v_fmac_f32 v26, v44, v20
v_fmac_f32 v27, v44, v21
v_lshlrev_b32 v20, 16, v74
v_and_b32 v21, s66, v74
v_fmac_f32 v28, v44, v20
v_fmac_f32 v29, v44, v21
v_lshlrev_b32 v20, 16, v75
v_and_b32 v21, s66, v75
v_fmac_f32 v30, v44, v20
v_fmac_f32 v31, v44, v21
s_waitcnt vmcnt(11)
v_lshlrev_b32 v45, 16, v45
v_lshlrev_b32 v20, 16, v76
v_and_b32 v21, s66, v76
v_fmac_f32 v24, v45, v20
v_fmac_f32 v25, v45, v21
v_lshlrev_b32 v20, 16, v77
v_and_b32 v21, s66, v77
v_fmac_f32 v26, v45, v20
v_fmac_f32 v27, v45, v21
v_lshlrev_b32 v20, 16, v78
v_and_b32 v21, s66, v78
v_fmac_f32 v28, v45, v20
v_fmac_f32 v29, v45, v21
v_lshlrev_b32 v20, 16, v79
v_and_b32 v21, s66, v79
v_fmac_f32 v30, v45, v20
v_fmac_f32 v31, v45, v21
s_waitcnt vmcnt(10)
v_lshlrev_b32 v46, 16, v46
v_lshlrev_b32 v20, 16, v80
v_and_b32 v21, s66, v80
v_fmac_f32 v24, v46, v20
v_fmac_f32 v25, v46, v21
v_lshlrev_b32 v20, 16, v81
v_and_b32 v21, s66, v81
v_fmac_f32 v26, v46, v20
v_fmac_f32 v27, v46, v21
v_lshlrev_b32 v20, 16, v82
v_and_b32 v21, s66, v82
v_fmac_f32 v28, v46, v20
v_fmac_f32 v29, v46, v21
v_lshlrev_b32 v20, 16, v83
v_and_b32 v21, s66, v83
v_fmac_f32 v30, v46, v20
v_fmac_f32 v31, v46, v21
s_waitcnt vmcnt(9)
v_lshlrev_b32 v47, 16, v47
v_lshlrev_b32 v20, 16, v84
v_and_b32 v21, s66, v84
v_fmac_f32 v24, v47, v20
v_fmac_f32 v25, v47, v21
v_lshlrev_b32 v20, 16, v85
v_and_b32 v21, s66, v85
v_fmac_f32 v26, v47, v20
v_fmac_f32 v27, v47, v21
v_lshlrev_b32 v20, 16, v86
v_and_b32 v21, s66, v86
v_fmac_f32 v28, v47, v20
v_fmac_f32 v29, v47, v21
v_lshlrev_b32 v20, 16, v87
v_and_b32 v21, s66, v87
v_fmac_f32 v30, v47, v20
v_fmac_f32 v31, v47, v21
s_waitcnt vmcnt(8)
s_cbranch_execz L_skip_6
buffer_load_dwordx4 v[128:131], v228, s[32:35], s61 offen nt
buffer_load_dwordx4 v[132:135], v229, s[32:35], s61 offen nt
buffer_load_dwordx4 v[136:139], v230, s[32:35], s61 offen nt
buffer_load_dwordx4 v[140:143], v231, s[32:35], s61 offen nt
L_skip_6:
v_lshlrev_b32 v48, 16, v48
v_lshlrev_b32 v20, 16, v88
v_and_b32 v21, s66, v88
v_fmac_f32 v24, v48, v20
v_fmac_f32 v25, v48, v21
v_lshlrev_b32 v20, 16, v89
v_and_b32 v21, s66, v89
v_fmac_f32 v26, v48, v20
v_fmac_f32 v27, v48, v21
v_lshlrev_b32 v20, 16, v90
v_and_b32 v21, s66, v90
v_fmac_f32 v28, v48, v20
v_fmac_f32 v29, v48, v21
v_lshlrev_b32 v20, 16, v91
v_and_b32 v21, s66, v91
v_fmac_f32 v30, v48, v20
v_fmac_f32 v31, v48, v21
v_lshrrev_b32 v20, 4, v3
v_and_b32 v21, 3, v3
v_lshlrev_b32 v21, 5, v21
v_lshl_add_u32 v20, v20, 7, v21
v_add_f32_dpp v24, v24, v24 row_ror:4 row_mask:0xf bank_mask:0xf
v_add_f32_dpp v25, v25, v25 row_ror:4 row_mask:0xf bank_mask:0xf
v_add_f32_dpp v26, v26, v26 row_ror:4 row_mask:0xf bank_mask:0xf
v_add_f32_dpp v27, v27, v27 row_ror:4 row_mask:0xf bank_mask:0xf
v_add_f32_dpp v28, v28, v28 row_ror:4 row_mask:0xf bank_mask:0xf
v_add_f32_dpp v29, v29, v29 row_ror:4 row_mask:0xf bank_mask:0xf
v_add_f32_dpp v30, v30, v30 row_ror:4 row_mask:0xf bank_mask:0xf
v_add_f32_dpp v31, v31, v31 row_ror:4 row_mask:0xf bank_mask:0xf
v_add_f32_dpp v24, v24, v24 row_ror:8 row_mask:0xf bank_mask:0xf
v_add_f32_dpp v25, v25, v25 row_ror:8 row_mask:0xf bank_mask:0xf
v_add_f32_dpp v26, v26, v26 row_ror:8 row_mask:0xf bank_mask:0xf
v_add_f32_dpp v27, v27, v27 row_ror:8 row_mask:0xf bank_mask:0xf
v_add_f32_dpp v28, v28, v28 row_ror:8 row_mask:0xf bank_mask:0xf
v_add_f32_dpp v29, v29, v29 row_ror:8 row_mask:0xf bank_mask:0xf
v_add_f32_dpp v30, v30, v30 row_ror:8 row_mask:0xf bank_mask:0xf
v_add_f32_dpp v31, v31, v31 row_ror:8 row_mask:0xf bank_mask:0xf
ds_write_b128 v20, v[24:27] offset:1024
ds_write_b128 v20, v[28:31] offset:1040
s_waitcnt lgkmcnt(0)
s_cbranch_execz L_svc2_4
s_barrier
s_add_u32 s73, s73, 0x9e3779b1
s_waitcnt vmcnt(4)
buffer_load_dwordx4 v[144:147], v232, s[36:39], s61 offen nt
buffer_load_dwordx4 v[148:151], v233, s[36:39], s61 offen nt
buffer_load_dwordx4 v[152:155], v234, s[36:39], s61 offen nt
buffer_load_dwordx4 v[156:159], v235, s[36:39], s61 offen nt
s_add_u32 s61, s61, s76
v_and_b32 v8, 1, v0
v_cmp_eq_u32 vcc, 1, v8
v_mov_b32 v9, 0xffff
v_mov_b32 v10, 0xffff0000
v_cndmask_b32 v9, v9, v10, vcc
v_bfe_u32 v8, v0, 1, 2
v_cmp_eq_u32 vcc, 0, v8
s_nop 1
v_cndmask_b32 v4, 0, v9, vcc
v_cmp_eq_u32 vcc, 1, v8
s_nop 1
v_cndmask_b32 v5, 0, v9, vcc
v_cmp_eq_u32 vcc, 2, v8
s_nop 1
v_cndmask_b32 v6, 0, v9, vcc
v_cmp_eq_u32 vcc, 3, v8
s_nop 1
v_cndmask_b32 v7, 0, v9, vcc
s_waitcnt vmcnt(4)
buffer_load_dwordx4 v[160:163], v228, s[32:35], s61 offen nt
buffer_load_dwordx4 v[164:167], v229, s[32:35], s61 offen nt
buffer_load_dwordx4 v[168:171], v230, s[32:35], s61 offen nt
buffer_load_dwordx4 v[172:175], v231, s[32:35], s61 offen nt
s_waitcnt vmcnt(4)
buffer_load_dwordx4 v[176:179], v232, s[36:39], s61 offen nt
buffer_load_dwordx4 v[180:183], v233, s[36:39], s61 offen nt
buffer_load_dwordx4 v[184:187], v234, s[36:39], s61 offen nt
buffer_load_dwordx4 v[188:191], v235, s[36:39], s61 offen nt
s_add_u32 s61, s61, s76
s_waitcnt vmcnt(4)
buffer_load_dwordx4 v[192:195], v228, s[32:35], s61 offen nt
buffer_load_dwordx4 v[196:199], v229, s[32:35], s61 offen nt
buffer_load_dwordx4 v[200:203], v230, s[32:35], s61 offen nt
buffer_load_dwordx4 v[204:207], v231, s[32:35], s61 offen nt
s_waitcnt vmcnt(4)
buffer_load_dwordx4 v[208:211], v232, s[36:39], s61 offen nt
buffer_load_dwordx4 v[212:215], v233, s[36:39], s61 offen nt
buffer_load_dwordx4 v[216:219], v234, s[36:39], s61 offen nt
buffer_load_dwordx4 v[220:223], v235, s[36:39], s61 offen nt
s_add_u32 s61, s61, s76
s_barrier
s_mov_b32 s67, 0x3fb8aa3b
s_mov_b32 s70, 0x01010101
s_mov_b32 s71, 0x01010101
s_mov_b32 s62, 0x3db504f3
s_mov_b32 s69, 0xffff0000
v_lshrrev_b32 v24, 4, v0
v_lshlrev_b32 v24, 4, v24
v_bfe_u32 v19, v0, 3, 1
v_lshl_add_u32 v24, v19, 8, v24
v_and_b32 v19, 1, v0
v_lshl_add_u32 v25, v19, 6, v24
ds_read_b128 v[236:239], v25 offset:0
ds_read_b128 v[240:243], v25 offset:128
v_mov_b32 v16, 0xff800000
s_lshl_b32 s65, s30, 13
s_add_u32 s65, s65, 26880
v_lshrrev_b32 v19, 4, v0
v_lshl_add_u32 v244, v19, 4, s65
v_bfe_u32 v19, v0, 3, 1
v_lshl_add_u32 v244, v19, 6, v244
s_waitcnt lgkmcnt(0)
s_mov_b32 s63, 8
L_pl_9:
s_cmp_lg_u32 s63, 1
s_cbranch_scc1 L_pn_10
s_mov_b32 s32, s98
s_mov_b32 s33, s99
s_mov_b32 s36, s98
s_mov_b32 s37, s99
s_add_u32 s61, s60, 0
s_mov_b32 s76, 32768
v_mov_b32 v228, v2
v_add_u32 v229, 1024, v2
v_add_u32 v230, 2048, v2
v_add_u32 v231, 3072, v2
v_add_u32 v232, 16384, v2
v_add_u32 v233, 17408, v2
v_add_u32 v234, 18432, v2
v_add_u32 v235, 19456, v2
L_pn_10:
s_waitcnt vmcnt(28)
v_mfma_f32_16x16x32_bf16 v[24:27], v[96:99], v[236:239], 0
v_mfma_f32_16x16x32_bf16 v[28:31], v[104:107], v[236:239], 0
v_mfma_f32_16x16x32_bf16 v[24:27], v[100:103], v[240:243], v[24:27]
v_mfma_f32_16x16x32_bf16 v[28:31], v[108:111], v[240:243], v[28:31]
s_waitcnt vmcnt(4)
buffer_load_dwordx4 v[96:99], v228, s[32:35], s61 offen nt
s_waitcnt vmcnt(4)
buffer_load_dwordx4 v[100:103], v229, s[32:35], s61 offen nt
s_waitcnt vmcnt(4)
buffer_load_dwordx4 v[104:107], v230, s[32:35], s61 offen nt
s_waitcnt vmcnt(5)
buffer_load_dwordx4 v[108:111], v231, s[32:35], s61 offen nt
s_nop 3
v_add_f32_dpp v8, v25, v24 quad_perm:[1,0,3,2] row_mask:0xf bank_mask:0xf
v_add_f32_dpp v9, v27, v26 quad_perm:[1,0,3,2] row_mask:0xf bank_mask:0xf
v_add_f32_dpp v10, v29, v28 quad_perm:[1,0,3,2] row_mask:0xf bank_mask:0xf
v_add_f32_dpp v11, v31, v30 quad_perm:[1,0,3,2] row_mask:0xf bank_mask:0xf
v_cvt_pk_bf16_f32 v36, v8, v9
v_cvt_pk_bf16_f32 v37, v10, v11
v_lshlrev_b32 v8, 16, v36
v_and_b32 v9, s69, v36
v_lshlrev_b32 v10, 16, v37
v_and_b32 v11, s69, v37
v_mul_f32 v8, s62, v8
v_mul_f32 v9, s62, v9
v_mul_f32 v10, s62, v10
v_mul_f32 v11, s62, v11
v_cvt_pk_bf16_f32 v36, v8, v9
v_cvt_pk_bf16_f32 v37, v10, v11
v_lshlrev_b32 v8, 16, v36
v_and_b32 v9, s69, v36
v_lshlrev_b32 v10, 16, v37
v_and_b32 v11, s69, v37
v_max3_f32 v16, v8, v9, v16
v_max3_f32 v16, v10, v11, v16
s_mov_b64 exec, s[70:71]
ds_write_b128 v244, v[8:11] offset:0
s_mov_b64 exec, -1
s_waitcnt vmcnt(28)
v_mfma_f32_16x16x32_bf16 v[24:27], v[112:115], v[236:239], 0
v_mfma_f32_16x16x32_bf16 v[28:31], v[120:123], v[236:239], 0
v_mfma_f32_16x16x32_bf16 v[24:27], v[116:119], v[240:243], v[24:27]
v_mfma_f32_16x16x32_bf16 v[28:31], v[124:127], v[240:243], v[28:31]
s_waitcnt vmcnt(4)
buffer_load_dwordx4 v[112:115], v232, s[36:39], s61 offen nt
s_waitcnt vmcnt(4)
buffer_load_dwordx4 v[116:119], v233, s[36:39], s61 offen nt
s_waitcnt vmcnt(4)
buffer_load_dwordx4 v[120:123], v234, s[36:39], s61 offen nt
s_waitcnt vmcnt(5)
buffer_load_dwordx4 v[124:127], v235, s[36:39], s61 offen nt
s_add_u32 s61, s61, s76
s_nop 3
v_add_f32_dpp v32, v25, v24 quad_perm:[1,0,3,2] row_mask:0xf bank_mask:0xf
v_add_f32_dpp v33, v27, v26 quad_perm:[1,0,3,2] row_mask:0xf bank_mask:0xf
v_add_f32_dpp v34, v29, v28 quad_perm:[1,0,3,2] row_mask:0xf bank_mask:0xf
v_add_f32_dpp v35, v31, v30 quad_perm:[1,0,3,2] row_mask:0xf bank_mask:0xf
v_cvt_pk_bf16_f32 v36, v32, v33
v_cvt_pk_bf16_f32 v37, v34, v35
v_lshlrev_b32 v32, 16, v36
v_and_b32 v33, s69, v36
v_lshlrev_b32 v34, 16, v37
v_and_b32 v35, s69, v37
v_mul_f32 v32, s62, v32
v_mul_f32 v33, s62, v33
v_mul_f32 v34, s62, v34
v_mul_f32 v35, s62, v35
v_cvt_pk_bf16_f32 v36, v32, v33
v_cvt_pk_bf16_f32 v37, v34, v35
v_lshlrev_b32 v32, 16, v36
v_and_b32 v33, s69, v36
v_lshlrev_b32 v34, 16, v37
v_and_b32 v35, s69, v37
v_max3_f32 v16, v32, v33, v16
v_max3_f32 v16, v34, v35, v16
s_mov_b64 exec, s[70:71]
ds_write_b128 v244, v[32:35] offset:128
s_mov_b64 exec, -1
s_waitcnt vmcnt(28)
v_mfma_f32_16x16x32_bf16 v[24:27], v[128:131], v[236:239], 0
v_mfma_f32_16x16x32_bf16 v[28:31], v[136:139], v[236:239], 0
v_mfma_f32_16x16x32_bf16 v[24:27], v[132:135], v[240:243], v[24:27]
v_mfma_f32_16x16x32_bf16 v[28:31], v[140:143], v[240:243], v[28:31]
s_waitcnt vmcnt(4)
buffer_load_dwordx4 v[128:131], v228, s[32:35], s61 offen nt
s_waitcnt vmcnt(4)
buffer_load_dwordx4 v[132:135], v229, s[32:35], s61 offen nt
s_waitcnt vmcnt(4)
buffer_load_dwordx4 v[136:139], v230, s[32:35], s61 offen nt
s_waitcnt vmcnt(5)
buffer_load_dwordx4 v[140:143], v231, s[32:35], s61 offen nt
s_nop 3
v_add_f32_dpp v8, v25, v24 quad_perm:[1,0,3,2] row_mask:0xf bank_mask:0xf
v_add_f32_dpp v9, v27, v26 quad_perm:[1,0,3,2] row_mask:0xf bank_mask:0xf
v_add_f32_dpp v10, v29, v28 quad_perm:[1,0,3,2] row_mask:0xf bank_mask:0xf
v_add_f32_dpp v11, v31, v30 quad_perm:[1,0,3,2] row_mask:0xf bank_mask:0xf
v_cvt_pk_bf16_f32 v36, v8, v9
v_cvt_pk_bf16_f32 v37, v10, v11
v_lshlrev_b32 v8, 16, v36
v_and_b32 v9, s69, v36
v_lshlrev_b32 v10, 16, v37
v_and_b32 v11, s69, v37
v_mul_f32 v8, s62, v8
v_mul_f32 v9, s62, v9
v_mul_f32 v10, s62, v10
v_mul_f32 v11, s62, v11
v_cvt_pk_bf16_f32 v36, v8, v9
v_cvt_pk_bf16_f32 v37, v10, v11
v_lshlrev_b32 v8, 16, v36
v_and_b32 v9, s69, v36
v_lshlrev_b32 v10, 16, v37
v_and_b32 v11, s69, v37
v_max3_f32 v16, v8, v9, v16
v_max3_f32 v16, v10, v11, v16
s_mov_b64 exec, s[70:71]
ds_write_b128 v244, v[8:11] offset:256
s_mov_b64 exec, -1
s_waitcnt vmcnt(28)
v_mfma_f32_16x16x32_bf16 v[24:27], v[144:147], v[236:239], 0
v_mfma_f32_16x16x32_bf16 v[28:31], v[152:155], v[236:239], 0
v_mfma_f32_16x16x32_bf16 v[24:27], v[148:151], v[240:243], v[24:27]
v_mfma_f32_16x16x32_bf16 v[28:31], v[156:159], v[240:243], v[28:31]
s_waitcnt vmcnt(4)
buffer_load_dwordx4 v[144:147], v232, s[36:39], s61 offen nt
s_waitcnt vmcnt(4)
buffer_load_dwordx4 v[148:151], v233, s[36:39], s61 offen nt
s_waitcnt vmcnt(4)
buffer_load_dwordx4 v[152:155], v234, s[36:39], s61 offen nt
s_waitcnt vmcnt(5)
buffer_load_dwordx4 v[156:159], v235, s[36:39], s61 offen nt
s_add_u32 s61, s61, s76
s_nop 3
v_add_f32_dpp v32, v25, v24 quad_perm:[1,0,3,2] row_mask:0xf bank_mask:0xf
v_add_f32_dpp v33, v27, v26 quad_perm:[1,0,3,2] row_mask:0xf bank_mask:0xf
v_add_f32_dpp v34, v29, v28 quad_perm:[1,0,3,2] row_mask:0xf bank_mask:0xf
v_add_f32_dpp v35, v31, v30 quad_perm:[1,0,3,2] row_mask:0xf bank_mask:0xf
v_cvt_pk_bf16_f32 v36, v32, v33
v_cvt_pk_bf16_f32 v37, v34, v35
v_lshlrev_b32 v32, 16, v36
v_and_b32 v33, s69, v36
v_lshlrev_b32 v34, 16, v37
v_and_b32 v35, s69, v37
v_mul_f32 v32, s62, v32
v_mul_f32 v33, s62, v33
v_mul_f32 v34, s62, v34
v_mul_f32 v35, s62, v35
v_cvt_pk_bf16_f32 v36, v32, v33
v_cvt_pk_bf16_f32 v37, v34, v35
v_lshlrev_b32 v32, 16, v36
v_and_b32 v33, s69, v36
v_lshlrev_b32 v34, 16, v37
v_and_b32 v35, s69, v37
v_max3_f32 v16, v32, v33, v16
v_max3_f32 v16, v34, v35, v16
s_mov_b64 exec, s[70:71]
ds_write_b128 v244, v[32:35] offset:384
s_mov_b64 exec, -1
s_waitcnt vmcnt(28)
v_mfma_f32_16x16x32_bf16 v[24:27], v[160:163], v[236:239], 0
v_mfma_f32_16x16x32_bf16 v[28:31], v[168:171], v[236:239], 0
v_mfma_f32_16x16x32_bf16 v[24:27], v[164:167], v[240:243], v[24:27]
v_mfma_f32_16x16x32_bf16 v[28:31], v[172:175], v[240:243], v[28:31]
s_waitcnt vmcnt(4)
buffer_load_dwordx4 v[160:163], v228, s[32:35], s61 offen nt
s_waitcnt vmcnt(4)
buffer_load_dwordx4 v[164:167], v229, s[32:35], s61 offen nt
s_waitcnt vmcnt(4)
buffer_load_dwordx4 v[168:171], v230, s[32:35], s61 offen nt
s_waitcnt vmcnt(5)
buffer_load_dwordx4 v[172:175], v231, s[32:35], s61 offen nt
s_nop 3
v_add_f32_dpp v8, v25, v24 quad_perm:[1,0,3,2] row_mask:0xf bank_mask:0xf
v_add_f32_dpp v9, v27, v26 quad_perm:[1,0,3,2] row_mask:0xf bank_mask:0xf
v_add_f32_dpp v10, v29, v28 quad_perm:[1,0,3,2] row_mask:0xf bank_mask:0xf
v_add_f32_dpp v11, v31, v30 quad_perm:[1,0,3,2] row_mask:0xf bank_mask:0xf
v_cvt_pk_bf16_f32 v36, v8, v9
v_cvt_pk_bf16_f32 v37, v10, v11
v_lshlrev_b32 v8, 16, v36
v_and_b32 v9, s69, v36
v_lshlrev_b32 v10, 16, v37
v_and_b32 v11, s69, v37
v_mul_f32 v8, s62, v8
v_mul_f32 v9, s62, v9
v_mul_f32 v10, s62, v10
v_mul_f32 v11, s62, v11
v_cvt_pk_bf16_f32 v36, v8, v9
v_cvt_pk_bf16_f32 v37, v10, v11
v_lshlrev_b32 v8, 16, v36
v_and_b32 v9, s69, v36
v_lshlrev_b32 v10, 16, v37
v_and_b32 v11, s69, v37
v_max3_f32 v16, v8, v9, v16
v_max3_f32 v16, v10, v11, v16
s_mov_b64 exec, s[70:71]
ds_write_b128 v244, v[8:11] offset:512
s_mov_b64 exec, -1
s_waitcnt vmcnt(28)
v_mfma_f32_16x16x32_bf16 v[24:27], v[176:179], v[236:239], 0
v_mfma_f32_16x16x32_bf16 v[28:31], v[184:187], v[236:239], 0
v_mfma_f32_16x16x32_bf16 v[24:27], v[180:183], v[240:243], v[24:27]
v_mfma_f32_16x16x32_bf16 v[28:31], v[188:191], v[240:243], v[28:31]
s_waitcnt vmcnt(4)
buffer_load_dwordx4 v[176:179], v232, s[36:39], s61 offen nt
s_waitcnt vmcnt(4)
buffer_load_dwordx4 v[180:183], v233, s[36:39], s61 offen nt
s_waitcnt vmcnt(4)
buffer_load_dwordx4 v[184:187], v234, s[36:39], s61 offen nt
s_waitcnt vmcnt(5)
buffer_load_dwordx4 v[188:191], v235, s[36:39], s61 offen nt
s_add_u32 s61, s61, s76
s_nop 3
v_add_f32_dpp v32, v25, v24 quad_perm:[1,0,3,2] row_mask:0xf bank_mask:0xf
v_add_f32_dpp v33, v27, v26 quad_perm:[1,0,3,2] row_mask:0xf bank_mask:0xf
v_add_f32_dpp v34, v29, v28 quad_perm:[1,0,3,2] row_mask:0xf bank_mask:0xf
v_add_f32_dpp v35, v31, v30 quad_perm:[1,0,3,2] row_mask:0xf bank_mask:0xf
v_cvt_pk_bf16_f32 v36, v32, v33
v_cvt_pk_bf16_f32 v37, v34, v35
v_lshlrev_b32 v32, 16, v36
v_and_b32 v33, s69, v36
v_lshlrev_b32 v34, 16, v37
v_and_b32 v35, s69, v37
v_mul_f32 v32, s62, v32
v_mul_f32 v33, s62, v33
v_mul_f32 v34, s62, v34
v_mul_f32 v35, s62, v35
v_cvt_pk_bf16_f32 v36, v32, v33
v_cvt_pk_bf16_f32 v37, v34, v35
v_lshlrev_b32 v32, 16, v36
v_and_b32 v33, s69, v36
v_lshlrev_b32 v34, 16, v37
v_and_b32 v35, s69, v37
v_max3_f32 v16, v32, v33, v16
v_max3_f32 v16, v34, v35, v16
s_mov_b64 exec, s[70:71]
ds_write_b128 v244, v[32:35] offset:640
s_mov_b64 exec, -1
s_waitcnt vmcnt(28)
v_mfma_f32_16x16x32_bf16 v[24:27], v[192:195], v[236:239], 0
v_mfma_f32_16x16x32_bf16 v[28:31], v[200:203], v[236:239], 0
v_mfma_f32_16x16x32_bf16 v[24:27], v[196:199], v[240:243], v[24:27]
v_mfma_f32_16x16x32_bf16 v[28:31], v[204:207], v[240:243], v[28:31]
s_waitcnt vmcnt(4)
buffer_load_dwordx4 v[192:195], v228, s[32:35], s61 offen nt
s_waitcnt vmcnt(4)
buffer_load_dwordx4 v[196:199], v229, s[32:35], s61 offen nt
s_waitcnt vmcnt(4)
buffer_load_dwordx4 v[200:203], v230, s[32:35], s61 offen nt
s_waitcnt vmcnt(5)
buffer_load_dwordx4 v[204:207], v231, s[32:35], s61 offen nt
s_nop 3
v_add_f32_dpp v8, v25, v24 quad_perm:[1,0,3,2] row_mask:0xf bank_mask:0xf
v_add_f32_dpp v9, v27, v26 quad_perm:[1,0,3,2] row_mask:0xf bank_mask:0xf
v_add_f32_dpp v10, v29, v28 quad_perm:[1,0,3,2] row_mask:0xf bank_mask:0xf
v_add_f32_dpp v11, v31, v30 quad_perm:[1,0,3,2] row_mask:0xf bank_mask:0xf
v_cvt_pk_bf16_f32 v36, v8, v9
v_cvt_pk_bf16_f32 v37, v10, v11
v_lshlrev_b32 v8, 16, v36
v_and_b32 v9, s69, v36
v_lshlrev_b32 v10, 16, v37
v_and_b32 v11, s69, v37
v_mul_f32 v8, s62, v8
v_mul_f32 v9, s62, v9
v_mul_f32 v10, s62, v10
v_mul_f32 v11, s62, v11
v_cvt_pk_bf16_f32 v36, v8, v9
v_cvt_pk_bf16_f32 v37, v10, v11
v_lshlrev_b32 v8, 16, v36
v_and_b32 v9, s69, v36
v_lshlrev_b32 v10, 16, v37
v_and_b32 v11, s69, v37
v_max3_f32 v16, v8, v9, v16
v_max3_f32 v16, v10, v11, v16
s_mov_b64 exec, s[70:71]
ds_write_b128 v244, v[8:11] offset:768
s_mov_b64 exec, -1
s_waitcnt vmcnt(28)
v_mfma_f32_16x16x32_bf16 v[24:27], v[208:211], v[236:239], 0
v_mfma_f32_16x16x32_bf16 v[28:31], v[216:219], v[236:239], 0
v_mfma_f32_16x16x32_bf16 v[24:27], v[212:215], v[240:243], v[24:27]
v_mfma_f32_16x16x32_bf16 v[28:31], v[220:223], v[240:243], v[28:31]
s_waitcnt vmcnt(4)
buffer_load_dwordx4 v[208:211], v232, s[36:39], s61 offen nt
s_waitcnt vmcnt(4)
buffer_load_dwordx4 v[212:215], v233, s[36:39], s61 offen nt
s_waitcnt vmcnt(4)
buffer_load_dwordx4 v[216:219], v234, s[36:39], s61 offen nt
s_waitcnt vmcnt(5)
buffer_load_dwordx4 v[220:223], v235, s[36:39], s61 offen nt
s_add_u32 s61, s61, s76
s_nop 3
v_add_f32_dpp v32, v25, v24 quad_perm:[1,0,3,2] row_mask:0xf bank_mask:0xf
v_add_f32_dpp v33, v27, v26 quad_perm:[1,0,3,2] row_mask:0xf bank_mask:0xf
v_add_f32_dpp v34, v29, v28 quad_perm:[1,0,3,2] row_mask:0xf bank_mask:0xf
v_add_f32_dpp v35, v31, v30 quad_perm:[1,0,3,2] row_mask:0xf bank_mask:0xf
v_cvt_pk_bf16_f32 v36, v32, v33
v_cvt_pk_bf16_f32 v37, v34, v35
v_lshlrev_b32 v32, 16, v36
v_and_b32 v33, s69, v36
v_lshlrev_b32 v34, 16, v37
v_and_b32 v35, s69, v37
v_mul_f32 v32, s62, v32
v_mul_f32 v33, s62, v33
v_mul_f32 v34, s62, v34
v_mul_f32 v35, s62, v35
v_cvt_pk_bf16_f32 v36, v32, v33
v_cvt_pk_bf16_f32 v37, v34, v35
v_lshlrev_b32 v32, 16, v36
v_and_b32 v33, s69, v36
v_lshlrev_b32 v34, 16, v37
v_and_b32 v35, s69, v37
v_max3_f32 v16, v32, v33, v16
v_max3_f32 v16, v34, v35, v16
s_mov_b64 exec, s[70:71]
ds_write_b128 v244, v[32:35] offset:896
s_mov_b64 exec, -1
v_add_u32 v244, 1024, v244
s_sub_u32 s63, s63, 1
s_cmp_lg_u32 s63, 0
s_cbranch_scc1 L_pl_9
v_mov_b32 v19, v16
s_nop 1
v_permlane32_swap_b32 v16, v19
v_max_f32 v16, v16, v19
v_mov_b32 v19, v16
s_nop 1
v_permlane16_swap_b32 v16, v19
v_max_f32 v16, v16, v19
s_nop 1
v_mov_b32_dpp v245, v16 row_newbcast:0 row_mask:0xf bank_mask:0x3
v_mov_b32_dpp v245, v16 row_newbcast:8 row_mask:0xf bank_mask:0xc
v_mov_b32 v16, v245
v_mul_f32 v17, s67, v245
v_mov_b32 v18, 0
v_mov_b32 v12, 0
v_mov_b32 v13, 0
v_mov_b32 v14, 0
v_mov_b32 v15, 0
s_lshl_b32 s65, s30, 13
s_add_u32 s65, s65, 26880
v_lshrrev_b32 v19, 4, v0
v_lshl_add_u32 v244, v19, 4, s65
v_bfe_u32 v19, v0, 3, 1
v_lshl_add_u32 v244, v19, 6, v244
s_mov_b32 s63, 8
L_pl_11:
s_cmp_lg_u32 s63, 1
s_cbranch_scc1 L_pn_12
s_mov_b32 s32, s52
s_mov_b32 s33, s53
s_mov_b32 s36, s52
s_mov_b32 s37, s53
s_add_u32 s61, s60, 0
s_mov_b32 s76, 32768
v_mov_b32 v228, v250
v_add_u32 v229, 128, v250
v_add_u32 v230, 2048, v250
v_add_u32 v231, 2176, v250
v_add_u32 v232, 16384, v250
v_add_u32 v233, 16512, v250
v_add_u32 v234, 18432, v250
v_add_u32 v235, 18560, v250
L_pn_12:
ds_read_b128 v[8:11], v244 offset:0
ds_read_b128 v[246:249], v244 offset:128
s_waitcnt lgkmcnt(1)
v_fma_f32 v20, v8, s67, -v17
v_fma_f32 v21, v9, s67, -v17
v_fma_f32 v22, v10, s67, -v17
v_fma_f32 v23, v11, s67, -v17
v_exp_f32 v20, v20
v_exp_f32 v21, v21
v_exp_f32 v22, v22
v_exp_f32 v23, v23
v_add_f32 v18, v18, v20
v_cvt_pk_bf16_f32 v20, v20, v20
v_add_f32 v18, v18, v21
v_cvt_pk_bf16_f32 v21, v21, v21
v_add_f32 v18, v18, v22
v_cvt_pk_bf16_f32 v22, v22, v22
v_add_f32 v18, v18, v23
v_cvt_pk_bf16_f32 v23, v23, v23
v_and_b32 v24, v20, v4
v_and_b32 v25, v20, v5
v_and_b32 v26, v20, v6
v_and_b32 v27, v20, v7
v_and_b32 v28, v21, v4
v_and_b32 v29, v21, v5
v_and_b32 v30, v21, v6
v_and_b32 v31, v21, v7
v_and_b32 v32, v22, v4
v_and_b32 v33, v22, v5
v_and_b32 v34, v22, v6
v_and_b32 v35, v22, v7
v_and_b32 v36, v23, v4
v_and_b32 v37, v23, v5
v_and_b32 v38, v23, v6
v_and_b32 v39, v23, v7
s_waitcnt vmcnt(28)
s_nop 0
v_mfma_f32_16x16x32_bf16 v[12:15], v[24:27], v[96:99], v[12:15]
v_mfma_f32_16x16x32_bf16 v[12:15], v[28:31], v[100:103], v[12:15]
v_mfma_f32_16x16x32_bf16 v[12:15], v[32:35], v[104:107], v[12:15]
v_mfma_f32_16x16x32_bf16 v[12:15], v[36:39], v[108:111], v[12:15]
s_waitcnt vmcnt(4)
buffer_load_dwordx4 v[96:99], v228, s[32:35], s61 offen nt
s_waitcnt vmcnt(4)
buffer_load_dwordx4 v[100:103], v229, s[32:35], s61 offen nt
s_waitcnt vmcnt(4)
buffer_load_dwordx4 v[104:107], v230, s[32:35], s61 offen nt
s_waitcnt vmcnt(5)
buffer_load_dwordx4 v[108:111], v231, s[32:35], s61 offen nt
s_waitcnt lgkmcnt(0)
v_fma_f32 v20, v246, s67, -v17
v_fma_f32 v21, v247, s67, -v17
v_fma_f32 v22, v248, s67, -v17
v_fma_f32 v23, v249, s67, -v17
v_exp_f32 v20, v20
v_exp_f32 v21, v21
v_exp_f32 v22, v22
v_exp_f32 v23, v23
v_add_f32 v18, v18, v20
v_cvt_pk_bf16_f32 v20, v20, v20
v_add_f32 v18, v18, v21
v_cvt_pk_bf16_f32 v21, v21, v21
v_add_f32 v18, v18, v22
v_cvt_pk_bf16_f32 v22, v22, v22
v_add_f32 v18, v18, v23
v_cvt_pk_bf16_f32 v23, v23, v23
v_and_b32 v24, v20, v4
v_and_b32 v25, v20, v5
v_and_b32 v26, v20, v6
v_and_b32 v27, v20, v7
v_and_b32 v28, v21, v4
v_and_b32 v29, v21, v5
v_and_b32 v30, v21, v6
v_and_b32 v31, v21, v7
v_and_b32 v32, v22, v4
v_and_b32 v33, v22, v5
v_and_b32 v34, v22, v6
v_and_b32 v35, v22, v7
v_and_b32 v36, v23, v4
v_and_b32 v37, v23, v5
v_and_b32 v38, v23, v6
v_and_b32 v39, v23, v7
s_waitcnt vmcnt(28)
s_nop 0
v_mfma_f32_16x16x32_bf16 v[12:15], v[24:27], v[112:115], v[12:15]
v_mfma_f32_16x16x32_bf16 v[12:15], v[28:31], v[116:119], v[12:15]
v_mfma_f32_16x16x32_bf16 v[12:15], v[32:35], v[120:123], v[12:15]
v_mfma_f32_16x16x32_bf16 v[12:15], v[36:39], v[124:127], v[12:15]
s_waitcnt vmcnt(4)
buffer_load_dwordx4 v[112:115], v232, s[36:39], s61 offen nt
s_waitcnt vmcnt(4)
buffer_load_dwordx4 v[116:119], v233, s[36:39], s61 offen nt
s_waitcnt vmcnt(4)
buffer_load_dwordx4 v[120:123], v234, s[36:39], s61 offen nt
s_waitcnt vmcnt(5)
buffer_load_dwordx4 v[124:127], v235, s[36:39], s61 offen nt
s_add_u32 s61, s61, s76
ds_read_b128 v[8:11], v244 offset:256
ds_read_b128 v[246:249], v244 offset:384
s_waitcnt lgkmcnt(1)
v_fma_f32 v20, v8, s67, -v17
v_fma_f32 v21, v9, s67, -v17
v_fma_f32 v22, v10, s67, -v17
v_fma_f32 v23, v11, s67, -v17
v_exp_f32 v20, v20
v_exp_f32 v21, v21
v_exp_f32 v22, v22
v_exp_f32 v23, v23
v_add_f32 v18, v18, v20
v_cvt_pk_bf16_f32 v20, v20, v20
v_add_f32 v18, v18, v21
v_cvt_pk_bf16_f32 v21, v21, v21
v_add_f32 v18, v18, v22
v_cvt_pk_bf16_f32 v22, v22, v22
v_add_f32 v18, v18, v23
v_cvt_pk_bf16_f32 v23, v23, v23
v_and_b32 v24, v20, v4
v_and_b32 v25, v20, v5
v_and_b32 v26, v20, v6
v_and_b32 v27, v20, v7
v_and_b32 v28, v21, v4
v_and_b32 v29, v21, v5
v_and_b32 v30, v21, v6
v_and_b32 v31, v21, v7
v_and_b32 v32, v22, v4
v_and_b32 v33, v22, v5
v_and_b32 v34, v22, v6
v_and_b32 v35, v22, v7
v_and_b32 v36, v23, v4
v_and_b32 v37, v23, v5
v_and_b32 v38, v23, v6
v_and_b32 v39, v23, v7
s_waitcnt vmcnt(28)
s_nop 0
v_mfma_f32_16x16x32_bf16 v[12:15], v[24:27], v[128:131], v[12:15]
v_mfma_f32_16x16x32_bf16 v[12:15], v[28:31], v[132:135], v[12:15]
v_mfma_f32_16x16x32_bf16 v[12:15], v[32:35], v[136:139], v[12:15]
v_mfma_f32_16x16x32_bf16 v[12:15], v[36:39], v[140:143], v[12:15]
s_waitcnt vmcnt(4)
buffer_load_dwordx4 v[128:131], v228, s[32:35], s61 offen nt
s_waitcnt vmcnt(4)
buffer_load_dwordx4 v[132:135], v229, s[32:35], s61 offen nt
s_waitcnt vmcnt(4)
buffer_load_dwordx4 v[136:139], v230, s[32:35], s61 offen nt
s_waitcnt vmcnt(5)
buffer_load_dwordx4 v[140:143], v231, s[32:35], s61 offen nt
s_waitcnt lgkmcnt(0)
v_fma_f32 v20, v246, s67, -v17
v_fma_f32 v21, v247, s67, -v17
v_fma_f32 v22, v248, s67, -v17
v_fma_f32 v23, v249, s67, -v17
v_exp_f32 v20, v20
v_exp_f32 v21, v21
v_exp_f32 v22, v22
v_exp_f32 v23, v23
v_add_f32 v18, v18, v20
v_cvt_pk_bf16_f32 v20, v20, v20
v_add_f32 v18, v18, v21
v_cvt_pk_bf16_f32 v21, v21, v21
v_add_f32 v18, v18, v22
v_cvt_pk_bf16_f32 v22, v22, v22
v_add_f32 v18, v18, v23
v_cvt_pk_bf16_f32 v23, v23, v23
v_and_b32 v24, v20, v4
v_and_b32 v25, v20, v5
v_and_b32 v26, v20, v6
v_and_b32 v27, v20, v7
v_and_b32 v28, v21, v4
v_and_b32 v29, v21, v5
v_and_b32 v30, v21, v6
v_and_b32 v31, v21, v7
v_and_b32 v32, v22, v4
v_and_b32 v33, v22, v5
v_and_b32 v34, v22, v6
v_and_b32 v35, v22, v7
v_and_b32 v36, v23, v4
v_and_b32 v37, v23, v5
v_and_b32 v38, v23, v6
v_and_b32 v39, v23, v7
s_waitcnt vmcnt(28)
s_nop 0
v_mfma_f32_16x16x32_bf16 v[12:15], v[24:27], v[144:147], v[12:15]
v_mfma_f32_16x16x32_bf16 v[12:15], v[28:31], v[148:151], v[12:15]
v_mfma_f32_16x16x32_bf16 v[12:15], v[32:35], v[152:155], v[12:15]
v_mfma_f32_16x16x32_bf16 v[12:15], v[36:39], v[156:159], v[12:15]
s_waitcnt vmcnt(4)
buffer_load_dwordx4 v[144:147], v232, s[36:39], s61 offen nt
s_waitcnt vmcnt(4)
buffer_load_dwordx4 v[148:151], v233, s[36:39], s61 offen nt
s_waitcnt vmcnt(4)
buffer_load_dwordx4 v[152:155], v234, s[36:39], s61 offen nt
s_waitcnt vmcnt(5)
buffer_load_dwordx4 v[156:159], v235, s[36:39], s61 offen nt
s_add_u32 s61, s61, s76
ds_read_b128 v[8:11], v244 offset:512
ds_read_b128 v[246:249], v244 offset:640
s_waitcnt lgkmcnt(1)
v_fma_f32 v20, v8, s67, -v17
v_fma_f32 v21, v9, s67, -v17
v_fma_f32 v22, v10, s67, -v17
v_fma_f32 v23, v11, s67, -v17
v_exp_f32 v20, v20
v_exp_f32 v21, v21
v_exp_f32 v22, v22
v_exp_f32 v23, v23
v_add_f32 v18, v18, v20
v_cvt_pk_bf16_f32 v20, v20, v20
v_add_f32 v18, v18, v21
v_cvt_pk_bf16_f32 v21, v21, v21
v_add_f32 v18, v18, v22
v_cvt_pk_bf16_f32 v22, v22, v22
v_add_f32 v18, v18, v23
v_cvt_pk_bf16_f32 v23, v23, v23
v_and_b32 v24, v20, v4
v_and_b32 v25, v20, v5
v_and_b32 v26, v20, v6
v_and_b32 v27, v20, v7
v_and_b32 v28, v21, v4
v_and_b32 v29, v21, v5
v_and_b32 v30, v21, v6
v_and_b32 v31, v21, v7
v_and_b32 v32, v22, v4
v_and_b32 v33, v22, v5
v_and_b32 v34, v22, v6
v_and_b32 v35, v22, v7
v_and_b32 v36, v23, v4
v_and_b32 v37, v23, v5
v_and_b32 v38, v23, v6
v_and_b32 v39, v23, v7
s_waitcnt vmcnt(28)
s_nop 0
v_mfma_f32_16x16x32_bf16 v[12:15], v[24:27], v[160:163], v[12:15]
v_mfma_f32_16x16x32_bf16 v[12:15], v[28:31], v[164:167], v[12:15]
v_mfma_f32_16x16x32_bf16 v[12:15], v[32:35], v[168:171], v[12:15]
v_mfma_f32_16x16x32_bf16 v[12:15], v[36:39], v[172:175], v[12:15]
s_waitcnt vmcnt(4)
buffer_load_dwordx4 v[160:163], v228, s[32:35], s61 offen nt
s_waitcnt vmcnt(4)
buffer_load_dwordx4 v[164:167], v229, s[32:35], s61 offen nt
s_waitcnt vmcnt(4)
buffer_load_dwordx4 v[168:171], v230, s[32:35], s61 offen nt
s_waitcnt vmcnt(5)
buffer_load_dwordx4 v[172:175], v231, s[32:35], s61 offen nt
s_waitcnt lgkmcnt(0)
v_fma_f32 v20, v246, s67, -v17
v_fma_f32 v21, v247, s67, -v17
v_fma_f32 v22, v248, s67, -v17
v_fma_f32 v23, v249, s67, -v17
v_exp_f32 v20, v20
v_exp_f32 v21, v21
v_exp_f32 v22, v22
v_exp_f32 v23, v23
v_add_f32 v18, v18, v20
v_cvt_pk_bf16_f32 v20, v20, v20
v_add_f32 v18, v18, v21
v_cvt_pk_bf16_f32 v21, v21, v21
v_add_f32 v18, v18, v22
v_cvt_pk_bf16_f32 v22, v22, v22
v_add_f32 v18, v18, v23
v_cvt_pk_bf16_f32 v23, v23, v23
v_and_b32 v24, v20, v4
v_and_b32 v25, v20, v5
v_and_b32 v26, v20, v6
v_and_b32 v27, v20, v7
v_and_b32 v28, v21, v4
v_and_b32 v29, v21, v5
v_and_b32 v30, v21, v6
v_and_b32 v31, v21, v7
v_and_b32 v32, v22, v4
v_and_b32 v33, v22, v5
v_and_b32 v34, v22, v6
v_and_b32 v35, v22, v7
v_and_b32 v36, v23, v4
v_and_b32 v37, v23, v5
v_and_b32 v38, v23, v6
v_and_b32 v39, v23, v7
s_waitcnt vmcnt(28)
s_nop 0
v_mfma_f32_16x16x32_bf16 v[12:15], v[24:27], v[176:179], v[12:15]
v_mfma_f32_16x16x32_bf16 v[12:15], v[28:31], v[180:183], v[12:15]
v_mfma_f32_16x16x32_bf16 v[12:15], v[32:35], v[184:187], v[12:15]
v_mfma_f32_16x16x32_bf16 v[12:15], v[36:39], v[188:191], v[12:15]
s_waitcnt vmcnt(4)
buffer_load_dwordx4 v[176:179], v232, s[36:39], s61 offen nt
s_waitcnt vmcnt(4)
buffer_load_dwordx4 v[180:183], v233, s[36:39], s61 offen nt
s_waitcnt vmcnt(4)
buffer_load_dwordx4 v[184:187], v234, s[36:39], s61 offen nt
s_waitcnt vmcnt(5)
buffer_load_dwordx4 v[188:191], v235, s[36:39], s61 offen nt
s_add_u32 s61, s61, s76
ds_read_b128 v[8:11], v244 offset:768
ds_read_b128 v[246:249], v244 offset:896
s_waitcnt lgkmcnt(1)
v_fma_f32 v20, v8, s67, -v17
v_fma_f32 v21, v9, s67, -v17
v_fma_f32 v22, v10, s67, -v17
v_fma_f32 v23, v11, s67, -v17
v_exp_f32 v20, v20
v_exp_f32 v21, v21
v_exp_f32 v22, v22
v_exp_f32 v23, v23
v_add_f32 v18, v18, v20
v_cvt_pk_bf16_f32 v20, v20, v20
v_add_f32 v18, v18, v21
v_cvt_pk_bf16_f32 v21, v21, v21
v_add_f32 v18, v18, v22
v_cvt_pk_bf16_f32 v22, v22, v22
v_add_f32 v18, v18, v23
v_cvt_pk_bf16_f32 v23, v23, v23
v_and_b32 v24, v20, v4
v_and_b32 v25, v20, v5
v_and_b32 v26, v20, v6
v_and_b32 v27, v20, v7
v_and_b32 v28, v21, v4
v_and_b32 v29, v21, v5
v_and_b32 v30, v21, v6
v_and_b32 v31, v21, v7
v_and_b32 v32, v22, v4
v_and_b32 v33, v22, v5
v_and_b32 v34, v22, v6
v_and_b32 v35, v22, v7
v_and_b32 v36, v23, v4
v_and_b32 v37, v23, v5
v_and_b32 v38, v23, v6
v_and_b32 v39, v23, v7
s_waitcnt vmcnt(28)
s_nop 0
v_mfma_f32_16x16x32_bf16 v[12:15], v[24:27], v[192:195], v[12:15]
v_mfma_f32_16x16x32_bf16 v[12:15], v[28:31], v[196:199], v[12:15]
v_mfma_f32_16x16x32_bf16 v[12:15], v[32:35], v[200:203], v[12:15]
v_mfma_f32_16x16x32_bf16 v[12:15], v[36:39], v[204:207], v[12:15]
s_waitcnt vmcnt(4)
buffer_load_dwordx4 v[192:195], v228, s[32:35], s61 offen nt
s_waitcnt vmcnt(4)
buffer_load_dwordx4 v[196:199], v229, s[32:35], s61 offen nt
s_waitcnt vmcnt(4)
buffer_load_dwordx4 v[200:203], v230, s[32:35], s61 offen nt
s_waitcnt vmcnt(5)
buffer_load_dwordx4 v[204:207], v231, s[32:35], s61 offen nt
s_waitcnt lgkmcnt(0)
v_fma_f32 v20, v246, s67, -v17
v_fma_f32 v21, v247, s67, -v17
v_fma_f32 v22, v248, s67, -v17
v_fma_f32 v23, v249, s67, -v17
v_exp_f32 v20, v20
v_exp_f32 v21, v21
v_exp_f32 v22, v22
v_exp_f32 v23, v23
v_add_f32 v18, v18, v20
v_cvt_pk_bf16_f32 v20, v20, v20
v_add_f32 v18, v18, v21
v_cvt_pk_bf16_f32 v21, v21, v21
v_add_f32 v18, v18, v22
v_cvt_pk_bf16_f32 v22, v22, v22
v_add_f32 v18, v18, v23
v_cvt_pk_bf16_f32 v23, v23, v23
v_and_b32 v24, v20, v4
v_and_b32 v25, v20, v5
v_and_b32 v26, v20, v6
v_and_b32 v27, v20, v7
v_and_b32 v28, v21, v4
v_and_b32 v29, v21, v5
v_and_b32 v30, v21, v6
v_and_b32 v31, v21, v7
v_and_b32 v32, v22, v4
v_and_b32 v33, v22, v5
v_and_b32 v34, v22, v6
v_and_b32 v35, v22, v7
v_and_b32 v36, v23, v4
v_and_b32 v37, v23, v5
v_and_b32 v38, v23, v6
v_and_b32 v39, v23, v7
s_waitcnt vmcnt(28)
s_nop 0
v_mfma_f32_16x16x32_bf16 v[12:15], v[24:27], v[208:211], v[12:15]
v_mfma_f32_16x16x32_bf16 v[12:15], v[28:31], v[212:215], v[12:15]
v_mfma_f32_16x16x32_bf16 v[12:15], v[32:35], v[216:219], v[12:15]
v_mfma_f32_16x16x32_bf16 v[12:15], v[36:39], v[220:223], v[12:15]
s_waitcnt vmcnt(4)
buffer_load_dwordx4 v[208:211], v232, s[36:39], s61 offen nt
s_waitcnt vmcnt(4)
buffer_load_dwordx4 v[212:215], v233, s[36:39], s61 offen nt
s_waitcnt vmcnt(4)
buffer_load_dwordx4 v[216:219], v234, s[36:39], s61 offen nt
s_waitcnt vmcnt(5)
buffer_load_dwordx4 v[220:223], v235, s[36:39], s61 offen nt
s_add_u32 s61, s61, s76
v_add_u32 v244, 1024, v244
s_sub_u32 s63, s63, 1
s_cmp_lg_u32 s63, 0
s_cbranch_scc1 L_pl_11
v_mov_b32 v19, v18
s_nop 1
v_permlane32_swap_b32 v18, v19
v_add_f32 v18, v18, v19
v_mov_b32 v19, v18
s_nop 1
v_permlane16_swap_b32 v18, v19
v_add_f32 v18, v18, v19
s_mul_i32 s65, s30, 1040
s_add_u32 s65, s65, 0
v_lshrrev_b32 v19, 5, v0
v_lshlrev_b32 v19, 9, v19
v_and_b32 v20, 15, v0
v_lshl_add_u32 v19, v20, 5, v19
v_bfe_u32 v20, v0, 4, 1
v_lshl_add_u32 v19, v20, 4, v19
v_add_u32 v19, s65, v19
v_bfe_u32 v20, v0, 3, 1
v_lshl_add_u32 v20, v20, 3, s65
v_mov_b32 v22, v17
v_mov_b32 v23, v18
ds_write_b128 v19, v[12:15] offset:3072
ds_write_b64 v20, v[22:23] offset:4096
s_waitcnt lgkmcnt(0)
s_cmp_lt_u32 s64, 8
s_cselect_b32 s44, s22, s12
s_cselect_b32 s45, s23, s13
s_and_b32 s65, s64, 7
s_lshl_b32 s65, s65, 5
s_lshl_b32 s66, s31, 8
s_add_u32 s65, s65, s66
s_mul_i32 s65, s65, 1152
s_add_u32 s44, s44, s65
s_addc_u32 s45, s45, 0
s_sub_u32 s46, 4718592, s65
s_mov_b32 s47, 0x20000
s_mul_i32 s65, s30, 9216
v_lshrrev_b32 v26, 4, v0
v_mul_u32_u24 v26, 2304, v26
v_and_b32 v27, 15, v0
v_lshl_add_u32 v26, v27, 4, v26
buffer_load_dwordx4 v[56:59], v26, s[44:47], s65 offen offset:0 nt
buffer_load_dwordx4 v[76:79], v26, s[44:47], s65 offen offset:1152 nt
buffer_load_dwordx4 v[60:63], v26, s[44:47], s65 offen offset:256 nt
buffer_load_dwordx4 v[80:83], v26, s[44:47], s65 offen offset:1408 nt
buffer_load_dwordx4 v[64:67], v26, s[44:47], s65 offen offset:512 nt
buffer_load_dwordx4 v[84:87], v26, s[44:47], s65 offen offset:1664 nt
buffer_load_dwordx4 v[68:71], v26, s[44:47], s65 offen offset:768 nt
buffer_load_dwordx4 v[88:91], v26, s[44:47], s65 offen offset:1920 nt
s_mov_b32 exec_lo, 0x00ff00ff
s_mov_b32 exec_hi, 0x00ff00ff
buffer_load_dwordx4 v[72:75], v26, s[44:47], s65 offen offset:1024 nt
buffer_load_dwordx4 v[92:95], v26, s[44:47], s65 offen offset:2176 nt
s_mov_b64 exec, -1
s_barrier
v_lshrrev_b32 v24, 4, v0
v_lshlrev_b32 v24, 4, v24
v_and_b32 v19, 1, v0
v_lshl_add_u32 v25, v19, 6, v24
ds_read_b128 v[236:239], v25 offset:512
ds_read_b128 v[240:243], v25 offset:640
v_mov_b32 v16, 0xff800000
s_lshl_b32 s65, s30, 13
s_add_u32 s65, s65, 26880
v_lshrrev_b32 v19, 4, v0
v_lshl_add_u32 v244, v19, 4, s65
s_waitcnt lgkmcnt(0)
s_mov_b32 s63, 8
L_pl_13:
s_cmp_lg_u32 s63, 1
s_cbranch_scc1 L_pn_14
s_mov_b32 s32, s56
s_mov_b32 s33, s57
s_mov_b32 s36, s56
s_mov_b32 s37, s57
s_add_u32 s61, s60, 0
s_mov_b32 s76, 32768
v_mov_b32 v228, v250
v_add_u32 v229, 128, v250
v_add_u32 v230, 2048, v250
v_add_u32 v231, 2176, v250
v_add_u32 v232, 16384, v250
v_add_u32 v233, 16512, v250
v_add_u32 v234, 18432, v250
v_add_u32 v235, 18560, v250
L_pn_14:
s_waitcnt vmcnt(28)
v_mfma_f32_16x16x32_bf16 v[24:27], v[96:99], v[236:239], 0
v_mfma_f32_16x16x32_bf16 v[28:31], v[104:107], v[236:239], 0
v_mfma_f32_16x16x32_bf16 v[24:27], v[100:103], v[240:243], v[24:27]
v_mfma_f32_16x16x32_bf16 v[28:31], v[108:111], v[240:243], v[28:31]
s_waitcnt vmcnt(4)
buffer_load_dwordx4 v[96:99], v228, s[32:35], s61 offen nt
s_waitcnt vmcnt(4)
buffer_load_dwordx4 v[100:103], v229, s[32:35], s61 offen nt
s_waitcnt vmcnt(4)
buffer_load_dwordx4 v[104:107], v230, s[32:35], s61 offen nt
s_waitcnt vmcnt(5)
buffer_load_dwordx4 v[108:111], v231, s[32:35], s61 offen nt
s_nop 3
v_add_f32_dpp v8, v25, v24 quad_perm:[1,0,3,2] row_mask:0xf bank_mask:0xf
v_add_f32_dpp v9, v27, v26 quad_perm:[1,0,3,2] row_mask:0xf bank_mask:0xf
v_add_f32_dpp v10, v29, v28 quad_perm:[1,0,3,2] row_mask:0xf bank_mask:0xf
v_add_f32_dpp v11, v31, v30 quad_perm:[1,0,3,2] row_mask:0xf bank_mask:0xf
v_cvt_pk_bf16_f32 v36, v8, v9
v_cvt_pk_bf16_f32 v37, v10, v11
v_lshlrev_b32 v8, 16, v36
v_and_b32 v9, s69, v36
v_lshlrev_b32 v10, 16, v37
v_and_b32 v11, s69, v37
v_mul_f32 v8, s62, v8
v_mul_f32 v9, s62, v9
v_mul_f32 v10, s62, v10
v_mul_f32 v11, s62, v11
v_cvt_pk_bf16_f32 v36, v8, v9
v_cvt_pk_bf16_f32 v37, v10, v11
v_lshlrev_b32 v8, 16, v36
v_and_b32 v9, s69, v36
v_lshlrev_b32 v10, 16, v37
v_and_b32 v11, s69, v37
v_max3_f32 v16, v8, v9, v16
v_max3_f32 v16, v10, v11, v16
s_mov_b64 exec, s[70:71]
ds_write_b128 v244, v[8:11] offset:0
s_mov_b64 exec, -1
s_waitcnt vmcnt(28)
v_mfma_f32_16x16x32_bf16 v[24:27], v[112:115], v[236:239], 0
v_mfma_f32_16x16x32_bf16 v[28:31], v[120:123], v[236:239], 0
v_mfma_f32_16x16x32_bf16 v[24:27], v[116:119], v[240:243], v[24:27]
v_mfma_f32_16x16x32_bf16 v[28:31], v[124:127], v[240:243], v[28:31]
s_waitcnt vmcnt(4)
buffer_load_dwordx4 v[112:115], v232, s[36:39], s61 offen nt
s_waitcnt vmcnt(4)
buffer_load_dwordx4 v[116:119], v233, s[36:39], s61 offen nt
s_waitcnt vmcnt(4)
buffer_load_dwordx4 v[120:123], v234, s[36:39], s61 offen nt
s_waitcnt vmcnt(5)
buffer_load_dwordx4 v[124:127], v235, s[36:39], s61 offen nt
s_add_u32 s61, s61, s76
s_nop 3
v_add_f32_dpp v32, v25, v24 quad_perm:[1,0,3,2] row_mask:0xf bank_mask:0xf
v_add_f32_dpp v33, v27, v26 quad_perm:[1,0,3,2] row_mask:0xf bank_mask:0xf
v_add_f32_dpp v34, v29, v28 quad_perm:[1,0,3,2] row_mask:0xf bank_mask:0xf
v_add_f32_dpp v35, v31, v30 quad_perm:[1,0,3,2] row_mask:0xf bank_mask:0xf
v_cvt_pk_bf16_f32 v36, v32, v33
v_cvt_pk_bf16_f32 v37, v34, v35
v_lshlrev_b32 v32, 16, v36
v_and_b32 v33, s69, v36
v_lshlrev_b32 v34, 16, v37
v_and_b32 v35, s69, v37
v_mul_f32 v32, s62, v32
v_mul_f32 v33, s62, v33
v_mul_f32 v34, s62, v34
v_mul_f32 v35, s62, v35
v_cvt_pk_bf16_f32 v36, v32, v33
v_cvt_pk_bf16_f32 v37, v34, v35
v_lshlrev_b32 v32, 16, v36
v_and_b32 v33, s69, v36
v_lshlrev_b32 v34, 16, v37
v_and_b32 v35, s69, v37
v_max3_f32 v16, v32, v33, v16
v_max3_f32 v16, v34, v35, v16
s_mov_b64 exec, s[70:71]
ds_write_b128 v244, v[32:35] offset:128
s_mov_b64 exec, -1
s_waitcnt vmcnt(28)
v_mfma_f32_16x16x32_bf16 v[24:27], v[128:131], v[236:239], 0
v_mfma_f32_16x16x32_bf16 v[28:31], v[136:139], v[236:239], 0
v_mfma_f32_16x16x32_bf16 v[24:27], v[132:135], v[240:243], v[24:27]
v_mfma_f32_16x16x32_bf16 v[28:31], v[140:143], v[240:243], v[28:31]
s_waitcnt vmcnt(4)
buffer_load_dwordx4 v[128:131], v228, s[32:35], s61 offen nt
s_waitcnt vmcnt(4)
buffer_load_dwordx4 v[132:135], v229, s[32:35], s61 offen nt
s_waitcnt vmcnt(4)
buffer_load_dwordx4 v[136:139], v230, s[32:35], s61 offen nt
s_waitcnt vmcnt(5)
buffer_load_dwordx4 v[140:143], v231, s[32:35], s61 offen nt
s_nop 3
v_add_f32_dpp v8, v25, v24 quad_perm:[1,0,3,2] row_mask:0xf bank_mask:0xf
v_add_f32_dpp v9, v27, v26 quad_perm:[1,0,3,2] row_mask:0xf bank_mask:0xf
v_add_f32_dpp v10, v29, v28 quad_perm:[1,0,3,2] row_mask:0xf bank_mask:0xf
v_add_f32_dpp v11, v31, v30 quad_perm:[1,0,3,2] row_mask:0xf bank_mask:0xf
v_cvt_pk_bf16_f32 v36, v8, v9
v_cvt_pk_bf16_f32 v37, v10, v11
v_lshlrev_b32 v8, 16, v36
v_and_b32 v9, s69, v36
v_lshlrev_b32 v10, 16, v37
v_and_b32 v11, s69, v37
v_mul_f32 v8, s62, v8
v_mul_f32 v9, s62, v9
v_mul_f32 v10, s62, v10
v_mul_f32 v11, s62, v11
v_cvt_pk_bf16_f32 v36, v8, v9
v_cvt_pk_bf16_f32 v37, v10, v11
v_lshlrev_b32 v8, 16, v36
v_and_b32 v9, s69, v36
v_lshlrev_b32 v10, 16, v37
v_and_b32 v11, s69, v37
v_max3_f32 v16, v8, v9, v16
v_max3_f32 v16, v10, v11, v16
s_mov_b64 exec, s[70:71]
ds_write_b128 v244, v[8:11] offset:256
s_mov_b64 exec, -1
s_waitcnt vmcnt(28)
v_mfma_f32_16x16x32_bf16 v[24:27], v[144:147], v[236:239], 0
v_mfma_f32_16x16x32_bf16 v[28:31], v[152:155], v[236:239], 0
v_mfma_f32_16x16x32_bf16 v[24:27], v[148:151], v[240:243], v[24:27]
v_mfma_f32_16x16x32_bf16 v[28:31], v[156:159], v[240:243], v[28:31]
s_waitcnt vmcnt(4)
buffer_load_dwordx4 v[144:147], v232, s[36:39], s61 offen nt
s_waitcnt vmcnt(4)
buffer_load_dwordx4 v[148:151], v233, s[36:39], s61 offen nt
s_waitcnt vmcnt(4)
buffer_load_dwordx4 v[152:155], v234, s[36:39], s61 offen nt
s_waitcnt vmcnt(5)
buffer_load_dwordx4 v[156:159], v235, s[36:39], s61 offen nt
s_add_u32 s61, s61, s76
s_nop 3
v_add_f32_dpp v32, v25, v24 quad_perm:[1,0,3,2] row_mask:0xf bank_mask:0xf
v_add_f32_dpp v33, v27, v26 quad_perm:[1,0,3,2] row_mask:0xf bank_mask:0xf
v_add_f32_dpp v34, v29, v28 quad_perm:[1,0,3,2] row_mask:0xf bank_mask:0xf
v_add_f32_dpp v35, v31, v30 quad_perm:[1,0,3,2] row_mask:0xf bank_mask:0xf
v_cvt_pk_bf16_f32 v36, v32, v33
v_cvt_pk_bf16_f32 v37, v34, v35
v_lshlrev_b32 v32, 16, v36
v_and_b32 v33, s69, v36
v_lshlrev_b32 v34, 16, v37
v_and_b32 v35, s69, v37
v_mul_f32 v32, s62, v32
v_mul_f32 v33, s62, v33
v_mul_f32 v34, s62, v34
v_mul_f32 v35, s62, v35
v_cvt_pk_bf16_f32 v36, v32, v33
v_cvt_pk_bf16_f32 v37, v34, v35
v_lshlrev_b32 v32, 16, v36
v_and_b32 v33, s69, v36
v_lshlrev_b32 v34, 16, v37
v_and_b32 v35, s69, v37
v_max3_f32 v16, v32, v33, v16
v_max3_f32 v16, v34, v35, v16
s_mov_b64 exec, s[70:71]
ds_write_b128 v244, v[32:35] offset:384
s_mov_b64 exec, -1
s_waitcnt vmcnt(28)
v_mfma_f32_16x16x32_bf16 v[24:27], v[160:163], v[236:239], 0
v_mfma_f32_16x16x32_bf16 v[28:31], v[168:171], v[236:239], 0
v_mfma_f32_16x16x32_bf16 v[24:27], v[164:167], v[240:243], v[24:27]
v_mfma_f32_16x16x32_bf16 v[28:31], v[172:175], v[240:243], v[28:31]
s_waitcnt vmcnt(4)
buffer_load_dwordx4 v[160:163], v228, s[32:35], s61 offen nt
s_waitcnt vmcnt(4)
buffer_load_dwordx4 v[164:167], v229, s[32:35], s61 offen nt
s_waitcnt vmcnt(4)
buffer_load_dwordx4 v[168:171], v230, s[32:35], s61 offen nt
s_waitcnt vmcnt(5)
buffer_load_dwordx4 v[172:175], v231, s[32:35], s61 offen nt
s_nop 3
v_add_f32_dpp v8, v25, v24 quad_perm:[1,0,3,2] row_mask:0xf bank_mask:0xf
v_add_f32_dpp v9, v27, v26 quad_perm:[1,0,3,2] row_mask:0xf bank_mask:0xf
v_add_f32_dpp v10, v29, v28 quad_perm:[1,0,3,2] row_mask:0xf bank_mask:0xf
v_add_f32_dpp v11, v31, v30 quad_perm:[1,0,3,2] row_mask:0xf bank_mask:0xf
v_cvt_pk_bf16_f32 v36, v8, v9
v_cvt_pk_bf16_f32 v37, v10, v11
v_lshlrev_b32 v8, 16, v36
v_and_b32 v9, s69, v36
v_lshlrev_b32 v10, 16, v37
v_and_b32 v11, s69, v37
v_mul_f32 v8, s62, v8
v_mul_f32 v9, s62, v9
v_mul_f32 v10, s62, v10
v_mul_f32 v11, s62, v11
v_cvt_pk_bf16_f32 v36, v8, v9
v_cvt_pk_bf16_f32 v37, v10, v11
v_lshlrev_b32 v8, 16, v36
v_and_b32 v9, s69, v36
v_lshlrev_b32 v10, 16, v37
v_and_b32 v11, s69, v37
v_max3_f32 v16, v8, v9, v16
v_max3_f32 v16, v10, v11, v16
s_mov_b64 exec, s[70:71]
ds_write_b128 v244, v[8:11] offset:512
s_mov_b64 exec, -1
s_waitcnt vmcnt(28)
v_mfma_f32_16x16x32_bf16 v[24:27], v[176:179], v[236:239], 0
v_mfma_f32_16x16x32_bf16 v[28:31], v[184:187], v[236:239], 0
v_mfma_f32_16x16x32_bf16 v[24:27], v[180:183], v[240:243], v[24:27]
v_mfma_f32_16x16x32_bf16 v[28:31], v[188:191], v[240:243], v[28:31]
s_waitcnt vmcnt(4)
buffer_load_dwordx4 v[176:179], v232, s[36:39], s61 offen nt
s_waitcnt vmcnt(4)
buffer_load_dwordx4 v[180:183], v233, s[36:39], s61 offen nt
s_waitcnt vmcnt(4)
buffer_load_dwordx4 v[184:187], v234, s[36:39], s61 offen nt
s_waitcnt vmcnt(5)
buffer_load_dwordx4 v[188:191], v235, s[36:39], s61 offen nt
s_add_u32 s61, s61, s76
s_nop 3
v_add_f32_dpp v32, v25, v24 quad_perm:[1,0,3,2] row_mask:0xf bank_mask:0xf
v_add_f32_dpp v33, v27, v26 quad_perm:[1,0,3,2] row_mask:0xf bank_mask:0xf
v_add_f32_dpp v34, v29, v28 quad_perm:[1,0,3,2] row_mask:0xf bank_mask:0xf
v_add_f32_dpp v35, v31, v30 quad_perm:[1,0,3,2] row_mask:0xf bank_mask:0xf
v_cvt_pk_bf16_f32 v36, v32, v33
v_cvt_pk_bf16_f32 v37, v34, v35
v_lshlrev_b32 v32, 16, v36
v_and_b32 v33, s69, v36
v_lshlrev_b32 v34, 16, v37
v_and_b32 v35, s69, v37
v_mul_f32 v32, s62, v32
v_mul_f32 v33, s62, v33
v_mul_f32 v34, s62, v34
v_mul_f32 v35, s62, v35
v_cvt_pk_bf16_f32 v36, v32, v33
v_cvt_pk_bf16_f32 v37, v34, v35
v_lshlrev_b32 v32, 16, v36
v_and_b32 v33, s69, v36
v_lshlrev_b32 v34, 16, v37
v_and_b32 v35, s69, v37
v_max3_f32 v16, v32, v33, v16
v_max3_f32 v16, v34, v35, v16
s_mov_b64 exec, s[70:71]
ds_write_b128 v244, v[32:35] offset:640
s_mov_b64 exec, -1
s_waitcnt vmcnt(28)
v_mfma_f32_16x16x32_bf16 v[24:27], v[192:195], v[236:239], 0
v_mfma_f32_16x16x32_bf16 v[28:31], v[200:203], v[236:239], 0
v_mfma_f32_16x16x32_bf16 v[24:27], v[196:199], v[240:243], v[24:27]
v_mfma_f32_16x16x32_bf16 v[28:31], v[204:207], v[240:243], v[28:31]
s_waitcnt vmcnt(4)
buffer_load_dwordx4 v[192:195], v228, s[32:35], s61 offen nt
s_waitcnt vmcnt(4)
buffer_load_dwordx4 v[196:199], v229, s[32:35], s61 offen nt
s_waitcnt vmcnt(4)
buffer_load_dwordx4 v[200:203], v230, s[32:35], s61 offen nt
s_waitcnt vmcnt(5)
buffer_load_dwordx4 v[204:207], v231, s[32:35], s61 offen nt
s_nop 3
v_add_f32_dpp v8, v25, v24 quad_perm:[1,0,3,2] row_mask:0xf bank_mask:0xf
v_add_f32_dpp v9, v27, v26 quad_perm:[1,0,3,2] row_mask:0xf bank_mask:0xf
v_add_f32_dpp v10, v29, v28 quad_perm:[1,0,3,2] row_mask:0xf bank_mask:0xf
v_add_f32_dpp v11, v31, v30 quad_perm:[1,0,3,2] row_mask:0xf bank_mask:0xf
v_cvt_pk_bf16_f32 v36, v8, v9
v_cvt_pk_bf16_f32 v37, v10, v11
v_lshlrev_b32 v8, 16, v36
v_and_b32 v9, s69, v36
v_lshlrev_b32 v10, 16, v37
v_and_b32 v11, s69, v37
v_mul_f32 v8, s62, v8
v_mul_f32 v9, s62, v9
v_mul_f32 v10, s62, v10
v_mul_f32 v11, s62, v11
v_cvt_pk_bf16_f32 v36, v8, v9
v_cvt_pk_bf16_f32 v37, v10, v11
v_lshlrev_b32 v8, 16, v36
v_and_b32 v9, s69, v36
v_lshlrev_b32 v10, 16, v37
v_and_b32 v11, s69, v37
v_max3_f32 v16, v8, v9, v16
v_max3_f32 v16, v10, v11, v16
s_mov_b64 exec, s[70:71]
ds_write_b128 v244, v[8:11] offset:768
s_mov_b64 exec, -1
s_waitcnt vmcnt(28)
v_mfma_f32_16x16x32_bf16 v[24:27], v[208:211], v[236:239], 0
v_mfma_f32_16x16x32_bf16 v[28:31], v[216:219], v[236:239], 0
v_mfma_f32_16x16x32_bf16 v[24:27], v[212:215], v[240:243], v[24:27]
v_mfma_f32_16x16x32_bf16 v[28:31], v[220:223], v[240:243], v[28:31]
s_waitcnt vmcnt(4)
buffer_load_dwordx4 v[208:211], v232, s[36:39], s61 offen nt
s_waitcnt vmcnt(4)
buffer_load_dwordx4 v[212:215], v233, s[36:39], s61 offen nt
s_waitcnt vmcnt(4)
buffer_load_dwordx4 v[216:219], v234, s[36:39], s61 offen nt
s_waitcnt vmcnt(5)
buffer_load_dwordx4 v[220:223], v235, s[36:39], s61 offen nt
s_add_u32 s61, s61, s76
s_nop 3
v_add_f32_dpp v32, v25, v24 quad_perm:[1,0,3,2] row_mask:0xf bank_mask:0xf
v_add_f32_dpp v33, v27, v26 quad_perm:[1,0,3,2] row_mask:0xf bank_mask:0xf
v_add_f32_dpp v34, v29, v28 quad_perm:[1,0,3,2] row_mask:0xf bank_mask:0xf
v_add_f32_dpp v35, v31, v30 quad_perm:[1,0,3,2] row_mask:0xf bank_mask:0xf
v_cvt_pk_bf16_f32 v36, v32, v33
v_cvt_pk_bf16_f32 v37, v34, v35
v_lshlrev_b32 v32, 16, v36
v_and_b32 v33, s69, v36
v_lshlrev_b32 v34, 16, v37
v_and_b32 v35, s69, v37
v_mul_f32 v32, s62, v32
v_mul_f32 v33, s62, v33
v_mul_f32 v34, s62, v34
v_mul_f32 v35, s62, v35
v_cvt_pk_bf16_f32 v36, v32, v33
v_cvt_pk_bf16_f32 v37, v34, v35
v_lshlrev_b32 v32, 16, v36
v_and_b32 v33, s69, v36
v_lshlrev_b32 v34, 16, v37
v_and_b32 v35, s69, v37
v_max3_f32 v16, v32, v33, v16
v_max3_f32 v16, v34, v35, v16
s_mov_b64 exec, s[70:71]
ds_write_b128 v244, v[32:35] offset:896
s_mov_b64 exec, -1
v_add_u32 v244, 1024, v244
s_sub_u32 s63, s63, 1
s_cmp_lg_u32 s63, 0
s_cbranch_scc1 L_pl_13
v_mov_b32 v19, v16
s_nop 1
v_permlane32_swap_b32 v16, v19
v_max_f32 v16, v16, v19
v_mov_b32 v19, v16
s_nop 1
v_permlane16_swap_b32 v16, v19
v_max_f32 v16, v16, v19
s_nop 1
v_mov_b32_dpp v245, v16 row_newbcast:0 row_mask:0xf bank_mask:0x3
v_mov_b32_dpp v245, v16 row_newbcast:8 row_mask:0xf bank_mask:0xc
v_lshrrev_b32 v24, 4, v0
v_lshlrev_b32 v24, 4, v24
v_and_b32 v19, 1, v0
v_lshl_add_u32 v25, v19, 6, v24
ds_read_b128 v[40:43], v24 offset:768
ds_read_b128 v[44:47], v24 offset:832
ds_read_b128 v[48:51], v24 offset:896
ds_read_b128 v[52:55], v24 offset:960
ds_read_b128 v[236:239], v25 offset:768
ds_read_b128 v[240:243], v25 offset:896
v_mov_b32 v16, 0xff800000
s_lshl_b32 s65, s30, 13
s_add_u32 s65, s65, 26944
v_lshrrev_b32 v19, 4, v0
v_lshl_add_u32 v244, v19, 4, s65
s_waitcnt lgkmcnt(0)
s_barrier
s_mov_b32 s63, 7
L_pl_15:
s_cmp_lg_u32 s63, 1
s_cbranch_scc1 L_pn_16
s_mov_b32 s32, s54
s_mov_b32 s33, s55
s_mov_b32 s36, s54
s_mov_b32 s37, s55
s_add_u32 s61, s60, 0
s_mov_b32 s76, 32768
v_mov_b32 v228, v2
v_add_u32 v229, 1024, v2
v_add_u32 v230, 2048, v2
v_add_u32 v231, 3072, v2
v_add_u32 v232, 16384, v2
v_add_u32 v233, 17408, v2
v_add_u32 v234, 18432, v2
v_add_u32 v235, 19456, v2
L_pn_16:
s_waitcnt vmcnt(28)
v_mfma_f32_16x16x32_bf16 v[24:27], v[96:99], v[236:239], 0
v_mfma_f32_16x16x32_bf16 v[28:31], v[104:107], v[236:239], 0
v_mfma_f32_16x16x32_bf16 v[24:27], v[100:103], v[240:243], v[24:27]
v_mfma_f32_16x16x32_bf16 v[28:31], v[108:111], v[240:243], v[28:31]
s_waitcnt vmcnt(4)
buffer_load_dwordx4 v[96:99], v228, s[32:35], s61 offen nt
s_waitcnt vmcnt(4)
buffer_load_dwordx4 v[100:103], v229, s[32:35], s61 offen nt
s_waitcnt vmcnt(4)
buffer_load_dwordx4 v[104:107], v230, s[32:35], s61 offen nt
s_waitcnt vmcnt(5)
buffer_load_dwordx4 v[108:111], v231, s[32:35], s61 offen nt
s_nop 3
v_add_f32_dpp v8, v25, v24 quad_perm:[1,0,3,2] row_mask:0xf bank_mask:0xf
v_add_f32_dpp v9, v27, v26 quad_perm:[1,0,3,2] row_mask:0xf bank_mask:0xf
v_add_f32_dpp v10, v29, v28 quad_perm:[1,0,3,2] row_mask:0xf bank_mask:0xf
v_add_f32_dpp v11, v31, v30 quad_perm:[1,0,3,2] row_mask:0xf bank_mask:0xf
v_cvt_pk_bf16_f32 v36, v8, v9
v_cvt_pk_bf16_f32 v37, v10, v11
v_lshlrev_b32 v8, 16, v36
v_and_b32 v9, s69, v36
v_lshlrev_b32 v10, 16, v37
v_and_b32 v11, s69, v37
v_mul_f32 v8, s62, v8
v_mul_f32 v9, s62, v9
v_mul_f32 v10, s62, v10
v_mul_f32 v11, s62, v11
v_cvt_pk_bf16_f32 v36, v8, v9
v_cvt_pk_bf16_f32 v37, v10, v11
v_lshlrev_b32 v8, 16, v36
v_and_b32 v9, s69, v36
v_lshlrev_b32 v10, 16, v37
v_and_b32 v11, s69, v37
v_max3_f32 v16, v8, v9, v16
v_max3_f32 v16, v10, v11, v16
s_mov_b64 exec, s[70:71]
ds_write_b128 v244, v[8:11] offset:0
s_mov_b64 exec, -1
s_waitcnt vmcnt(28)
v_mfma_f32_16x16x32_bf16 v[24:27], v[112:115], v[236:239], 0
v_mfma_f32_16x16x32_bf16 v[28:31], v[120:123], v[236:239], 0
v_mfma_f32_16x16x32_bf16 v[24:27], v[116:119], v[240:243], v[24:27]
v_mfma_f32_16x16x32_bf16 v[28:31], v[124:127], v[240:243], v[28:31]
s_waitcnt vmcnt(4)
buffer_load_dwordx4 v[112:115], v232, s[36:39], s61 offen nt
s_waitcnt vmcnt(4)
buffer_load_dwordx4 v[116:119], v233, s[36:39], s61 offen nt
s_waitcnt vmcnt(4)
buffer_load_dwordx4 v[120:123], v234, s[36:39], s61 offen nt
s_waitcnt vmcnt(5)
buffer_load_dwordx4 v[124:127], v235, s[36:39], s61 offen nt
s_add_u32 s61, s61, s76
s_nop 3
v_add_f32_dpp v32, v25, v24 quad_perm:[1,0,3,2] row_mask:0xf bank_mask:0xf
v_add_f32_dpp v33, v27, v26 quad_perm:[1,0,3,2] row_mask:0xf bank_mask:0xf
v_add_f32_dpp v34, v29, v28 quad_perm:[1,0,3,2] row_mask:0xf bank_mask:0xf
v_add_f32_dpp v35, v31, v30 quad_perm:[1,0,3,2] row_mask:0xf bank_mask:0xf
v_cvt_pk_bf16_f32 v36, v32, v33
v_cvt_pk_bf16_f32 v37, v34, v35
v_lshlrev_b32 v32, 16, v36
v_and_b32 v33, s69, v36
v_lshlrev_b32 v34, 16, v37
v_and_b32 v35, s69, v37
v_mul_f32 v32, s62, v32
v_mul_f32 v33, s62, v33
v_mul_f32 v34, s62, v34
v_mul_f32 v35, s62, v35
v_cvt_pk_bf16_f32 v36, v32, v33
v_cvt_pk_bf16_f32 v37, v34, v35
v_lshlrev_b32 v32, 16, v36
v_and_b32 v33, s69, v36
v_lshlrev_b32 v34, 16, v37
v_and_b32 v35, s69, v37
v_max3_f32 v16, v32, v33, v16
v_max3_f32 v16, v34, v35, v16
s_mov_b64 exec, s[70:71]
ds_write_b128 v244, v[32:35] offset:128
s_mov_b64 exec, -1
s_waitcnt vmcnt(28)
v_mfma_f32_16x16x32_bf16 v[24:27], v[128:131], v[236:239], 0
v_mfma_f32_16x16x32_bf16 v[28:31], v[136:139], v[236:239], 0
v_mfma_f32_16x16x32_bf16 v[24:27], v[132:135], v[240:243], v[24:27]
v_mfma_f32_16x16x32_bf16 v[28:31], v[140:143], v[240:243], v[28:31]
s_waitcnt vmcnt(4)
buffer_load_dwordx4 v[128:131], v228, s[32:35], s61 offen nt
s_waitcnt vmcnt(4)
buffer_load_dwordx4 v[132:135], v229, s[32:35], s61 offen nt
s_waitcnt vmcnt(4)
buffer_load_dwordx4 v[136:139], v230, s[32:35], s61 offen nt
s_waitcnt vmcnt(5)
buffer_load_dwordx4 v[140:143], v231, s[32:35], s61 offen nt
s_nop 3
v_add_f32_dpp v8, v25, v24 quad_perm:[1,0,3,2] row_mask:0xf bank_mask:0xf
v_add_f32_dpp v9, v27, v26 quad_perm:[1,0,3,2] row_mask:0xf bank_mask:0xf
v_add_f32_dpp v10, v29, v28 quad_perm:[1,0,3,2] row_mask:0xf bank_mask:0xf
v_add_f32_dpp v11, v31, v30 quad_perm:[1,0,3,2] row_mask:0xf bank_mask:0xf
v_cvt_pk_bf16_f32 v36, v8, v9
v_cvt_pk_bf16_f32 v37, v10, v11
v_lshlrev_b32 v8, 16, v36
v_and_b32 v9, s69, v36
v_lshlrev_b32 v10, 16, v37
v_and_b32 v11, s69, v37
v_mul_f32 v8, s62, v8
v_mul_f32 v9, s62, v9
v_mul_f32 v10, s62, v10
v_mul_f32 v11, s62, v11
v_cvt_pk_bf16_f32 v36, v8, v9
v_cvt_pk_bf16_f32 v37, v10, v11
v_lshlrev_b32 v8, 16, v36
v_and_b32 v9, s69, v36
v_lshlrev_b32 v10, 16, v37
v_and_b32 v11, s69, v37
v_max3_f32 v16, v8, v9, v16
v_max3_f32 v16, v10, v11, v16
s_mov_b64 exec, s[70:71]
ds_write_b128 v244, v[8:11] offset:256
s_mov_b64 exec, -1
s_waitcnt vmcnt(28)
v_mfma_f32_16x16x32_bf16 v[24:27], v[144:147], v[236:239], 0
v_mfma_f32_16x16x32_bf16 v[28:31], v[152:155], v[236:239], 0
v_mfma_f32_16x16x32_bf16 v[24:27], v[148:151], v[240:243], v[24:27]
v_mfma_f32_16x16x32_bf16 v[28:31], v[156:159], v[240:243], v[28:31]
s_waitcnt vmcnt(4)
buffer_load_dwordx4 v[144:147], v232, s[36:39], s61 offen nt
s_waitcnt vmcnt(4)
buffer_load_dwordx4 v[148:151], v233, s[36:39], s61 offen nt
s_waitcnt vmcnt(4)
buffer_load_dwordx4 v[152:155], v234, s[36:39], s61 offen nt
s_waitcnt vmcnt(5)
buffer_load_dwordx4 v[156:159], v235, s[36:39], s61 offen nt
s_add_u32 s61, s61, s76
s_nop 3
v_add_f32_dpp v32, v25, v24 quad_perm:[1,0,3,2] row_mask:0xf bank_mask:0xf
v_add_f32_dpp v33, v27, v26 quad_perm:[1,0,3,2] row_mask:0xf bank_mask:0xf
v_add_f32_dpp v34, v29, v28 quad_perm:[1,0,3,2] row_mask:0xf bank_mask:0xf
v_add_f32_dpp v35, v31, v30 quad_perm:[1,0,3,2] row_mask:0xf bank_mask:0xf
v_cvt_pk_bf16_f32 v36, v32, v33
v_cvt_pk_bf16_f32 v37, v34, v35
v_lshlrev_b32 v32, 16, v36
v_and_b32 v33, s69, v36
v_lshlrev_b32 v34, 16, v37
v_and_b32 v35, s69, v37
v_mul_f32 v32, s62, v32
v_mul_f32 v33, s62, v33
v_mul_f32 v34, s62, v34
v_mul_f32 v35, s62, v35
v_cvt_pk_bf16_f32 v36, v32, v33
v_cvt_pk_bf16_f32 v37, v34, v35
v_lshlrev_b32 v32, 16, v36
v_and_b32 v33, s69, v36
v_lshlrev_b32 v34, 16, v37
v_and_b32 v35, s69, v37
v_max3_f32 v16, v32, v33, v16
v_max3_f32 v16, v34, v35, v16
s_mov_b64 exec, s[70:71]
ds_write_b128 v244, v[32:35] offset:384
s_mov_b64 exec, -1
s_waitcnt vmcnt(28)
v_mfma_f32_16x16x32_bf16 v[24:27], v[160:163], v[236:239], 0
v_mfma_f32_16x16x32_bf16 v[28:31], v[168:171], v[236:239], 0
v_mfma_f32_16x16x32_bf16 v[24:27], v[164:167], v[240:243], v[24:27]
v_mfma_f32_16x16x32_bf16 v[28:31], v[172:175], v[240:243], v[28:31]
s_waitcnt vmcnt(4)
buffer_load_dwordx4 v[160:163], v228, s[32:35], s61 offen nt
s_waitcnt vmcnt(4)
buffer_load_dwordx4 v[164:167], v229, s[32:35], s61 offen nt
s_waitcnt vmcnt(4)
buffer_load_dwordx4 v[168:171], v230, s[32:35], s61 offen nt
s_waitcnt vmcnt(5)
buffer_load_dwordx4 v[172:175], v231, s[32:35], s61 offen nt
s_nop 3
v_add_f32_dpp v8, v25, v24 quad_perm:[1,0,3,2] row_mask:0xf bank_mask:0xf
v_add_f32_dpp v9, v27, v26 quad_perm:[1,0,3,2] row_mask:0xf bank_mask:0xf
v_add_f32_dpp v10, v29, v28 quad_perm:[1,0,3,2] row_mask:0xf bank_mask:0xf
v_add_f32_dpp v11, v31, v30 quad_perm:[1,0,3,2] row_mask:0xf bank_mask:0xf
v_cvt_pk_bf16_f32 v36, v8, v9
v_cvt_pk_bf16_f32 v37, v10, v11
v_lshlrev_b32 v8, 16, v36
v_and_b32 v9, s69, v36
v_lshlrev_b32 v10, 16, v37
v_and_b32 v11, s69, v37
v_mul_f32 v8, s62, v8
v_mul_f32 v9, s62, v9
v_mul_f32 v10, s62, v10
v_mul_f32 v11, s62, v11
v_cvt_pk_bf16_f32 v36, v8, v9
v_cvt_pk_bf16_f32 v37, v10, v11
v_lshlrev_b32 v8, 16, v36
v_and_b32 v9, s69, v36
v_lshlrev_b32 v10, 16, v37
v_and_b32 v11, s69, v37
v_max3_f32 v16, v8, v9, v16
v_max3_f32 v16, v10, v11, v16
s_mov_b64 exec, s[70:71]
ds_write_b128 v244, v[8:11] offset:512
s_mov_b64 exec, -1
s_waitcnt vmcnt(28)
v_mfma_f32_16x16x32_bf16 v[24:27], v[176:179], v[236:239], 0
v_mfma_f32_16x16x32_bf16 v[28:31], v[184:187], v[236:239], 0
v_mfma_f32_16x16x32_bf16 v[24:27], v[180:183], v[240:243], v[24:27]
v_mfma_f32_16x16x32_bf16 v[28:31], v[188:191], v[240:243], v[28:31]
s_waitcnt vmcnt(4)
buffer_load_dwordx4 v[176:179], v232, s[36:39], s61 offen nt
s_waitcnt vmcnt(4)
buffer_load_dwordx4 v[180:183], v233, s[36:39], s61 offen nt
s_waitcnt vmcnt(4)
buffer_load_dwordx4 v[184:187], v234, s[36:39], s61 offen nt
s_waitcnt vmcnt(5)
buffer_load_dwordx4 v[188:191], v235, s[36:39], s61 offen nt
s_add_u32 s61, s61, s76
s_nop 3
v_add_f32_dpp v32, v25, v24 quad_perm:[1,0,3,2] row_mask:0xf bank_mask:0xf
v_add_f32_dpp v33, v27, v26 quad_perm:[1,0,3,2] row_mask:0xf bank_mask:0xf
v_add_f32_dpp v34, v29, v28 quad_perm:[1,0,3,2] row_mask:0xf bank_mask:0xf
v_add_f32_dpp v35, v31, v30 quad_perm:[1,0,3,2] row_mask:0xf bank_mask:0xf
v_cvt_pk_bf16_f32 v36, v32, v33
v_cvt_pk_bf16_f32 v37, v34, v35
v_lshlrev_b32 v32, 16, v36
v_and_b32 v33, s69, v36
v_lshlrev_b32 v34, 16, v37
v_and_b32 v35, s69, v37
v_mul_f32 v32, s62, v32
v_mul_f32 v33, s62, v33
v_mul_f32 v34, s62, v34
v_mul_f32 v35, s62, v35
v_cvt_pk_bf16_f32 v36, v32, v33
v_cvt_pk_bf16_f32 v37, v34, v35
v_lshlrev_b32 v32, 16, v36
v_and_b32 v33, s69, v36
v_lshlrev_b32 v34, 16, v37
v_and_b32 v35, s69, v37
v_max3_f32 v16, v32, v33, v16
v_max3_f32 v16, v34, v35, v16
s_mov_b64 exec, s[70:71]
ds_write_b128 v244, v[32:35] offset:640
s_mov_b64 exec, -1
s_waitcnt vmcnt(28)
v_mfma_f32_16x16x32_bf16 v[24:27], v[192:195], v[236:239], 0
v_mfma_f32_16x16x32_bf16 v[28:31], v[200:203], v[236:239], 0
v_mfma_f32_16x16x32_bf16 v[24:27], v[196:199], v[240:243], v[24:27]
v_mfma_f32_16x16x32_bf16 v[28:31], v[204:207], v[240:243], v[28:31]
s_waitcnt vmcnt(4)
buffer_load_dwordx4 v[192:195], v228, s[32:35], s61 offen nt
s_waitcnt vmcnt(4)
buffer_load_dwordx4 v[196:199], v229, s[32:35], s61 offen nt
s_waitcnt vmcnt(4)
buffer_load_dwordx4 v[200:203], v230, s[32:35], s61 offen nt
s_waitcnt vmcnt(5)
buffer_load_dwordx4 v[204:207], v231, s[32:35], s61 offen nt
s_nop 3
v_add_f32_dpp v8, v25, v24 quad_perm:[1,0,3,2] row_mask:0xf bank_mask:0xf
v_add_f32_dpp v9, v27, v26 quad_perm:[1,0,3,2] row_mask:0xf bank_mask:0xf
v_add_f32_dpp v10, v29, v28 quad_perm:[1,0,3,2] row_mask:0xf bank_mask:0xf
v_add_f32_dpp v11, v31, v30 quad_perm:[1,0,3,2] row_mask:0xf bank_mask:0xf
v_cvt_pk_bf16_f32 v36, v8, v9
v_cvt_pk_bf16_f32 v37, v10, v11
v_lshlrev_b32 v8, 16, v36
v_and_b32 v9, s69, v36
v_lshlrev_b32 v10, 16, v37
v_and_b32 v11, s69, v37
v_mul_f32 v8, s62, v8
v_mul_f32 v9, s62, v9
v_mul_f32 v10, s62, v10
v_mul_f32 v11, s62, v11
v_cvt_pk_bf16_f32 v36, v8, v9
v_cvt_pk_bf16_f32 v37, v10, v11
v_lshlrev_b32 v8, 16, v36
v_and_b32 v9, s69, v36
v_lshlrev_b32 v10, 16, v37
v_and_b32 v11, s69, v37
v_max3_f32 v16, v8, v9, v16
v_max3_f32 v16, v10, v11, v16
s_mov_b64 exec, s[70:71]
ds_write_b128 v244, v[8:11] offset:768
s_mov_b64 exec, -1
s_waitcnt vmcnt(28)
v_mfma_f32_16x16x32_bf16 v[24:27], v[208:211], v[236:239], 0
v_mfma_f32_16x16x32_bf16 v[28:31], v[216:219], v[236:239], 0
v_mfma_f32_16x16x32_bf16 v[24:27], v[212:215], v[240:243], v[24:27]
v_mfma_f32_16x16x32_bf16 v[28:31], v[220:223], v[240:243], v[28:31]
s_waitcnt vmcnt(4)
buffer_load_dwordx4 v[208:211], v232, s[36:39], s61 offen nt
s_waitcnt vmcnt(4)
buffer_load_dwordx4 v[212:215], v233, s[36:39], s61 offen nt
s_waitcnt vmcnt(4)
buffer_load_dwordx4 v[216:219], v234, s[36:39], s61 offen nt
s_waitcnt vmcnt(5)
buffer_load_dwordx4 v[220:223], v235, s[36:39], s61 offen nt
s_add_u32 s61, s61, s76
s_nop 3
v_add_f32_dpp v32, v25, v24 quad_perm:[1,0,3,2] row_mask:0xf bank_mask:0xf
v_add_f32_dpp v33, v27, v26 quad_perm:[1,0,3,2] row_mask:0xf bank_mask:0xf
v_add_f32_dpp v34, v29, v28 quad_perm:[1,0,3,2] row_mask:0xf bank_mask:0xf
v_add_f32_dpp v35, v31, v30 quad_perm:[1,0,3,2] row_mask:0xf bank_mask:0xf
v_cvt_pk_bf16_f32 v36, v32, v33
v_cvt_pk_bf16_f32 v37, v34, v35
v_lshlrev_b32 v32, 16, v36
v_and_b32 v33, s69, v36
v_lshlrev_b32 v34, 16, v37
v_and_b32 v35, s69, v37
v_mul_f32 v32, s62, v32
v_mul_f32 v33, s62, v33
v_mul_f32 v34, s62, v34
v_mul_f32 v35, s62, v35
v_cvt_pk_bf16_f32 v36, v32, v33
v_cvt_pk_bf16_f32 v37, v34, v35
v_lshlrev_b32 v32, 16, v36
v_and_b32 v33, s69, v36
v_lshlrev_b32 v34, 16, v37
v_and_b32 v35, s69, v37
v_max3_f32 v16, v32, v33, v16
v_max3_f32 v16, v34, v35, v16
s_mov_b64 exec, s[70:71]
ds_write_b128 v244, v[32:35] offset:896
s_mov_b64 exec, -1
v_add_u32 v244, 1024, v244
s_sub_u32 s63, s63, 1
s_cmp_lg_u32 s63, 0
s_cbranch_scc1 L_pl_15
v_mov_b32 v19, v16
s_nop 1
v_permlane32_swap_b32 v16, v19
v_max_f32 v16, v16, v19
v_mov_b32 v19, v16
s_nop 1
v_permlane16_swap_b32 v16, v19
v_max_f32 v16, v16, v19
s_nop 1
v_mov_b32_dpp v227, v16 row_newbcast:0 row_mask:0xf bank_mask:0x3
v_mov_b32_dpp v227, v16 row_newbcast:8 row_mask:0xf bank_mask:0xc
v_mov_b32 v16, v245
v_mul_f32 v17, s67, v245
v_mov_b32 v18, 0
v_mov_b32 v12, 0
v_mov_b32 v13, 0
v_mov_b32 v14, 0
v_mov_b32 v15, 0
s_lshl_b32 s65, s30, 13
s_add_u32 s65, s65, 26880
v_lshrrev_b32 v19, 4, v0
v_lshl_add_u32 v244, v19, 4, s65
s_barrier
s_mov_b32 s63, 8
L_pl_17:
s_cmp_lg_u32 s63, 1
s_cbranch_scc1 L_pn_18
s_mov_b32 s32, s58
s_mov_b32 s33, s59
s_mov_b32 s36, s58
s_mov_b32 s37, s59
s_add_u32 s61, s60, 0
s_mov_b32 s76, 32768
v_mov_b32 v228, v2
v_add_u32 v229, 1024, v2
v_add_u32 v230, 2048, v2
v_add_u32 v231, 3072, v2
v_add_u32 v232, 16384, v2
v_add_u32 v233, 17408, v2
v_add_u32 v234, 18432, v2
v_add_u32 v235, 19456, v2
L_pn_18:
ds_read_b128 v[8:11], v244 offset:0
ds_read_b128 v[246:249], v244 offset:128
s_waitcnt lgkmcnt(1)
v_fma_f32 v20, v8, s67, -v17
v_fma_f32 v21, v9, s67, -v17
v_fma_f32 v22, v10, s67, -v17
v_fma_f32 v23, v11, s67, -v17
v_exp_f32 v20, v20
v_exp_f32 v21, v21
v_exp_f32 v22, v22
v_exp_f32 v23, v23
v_add_f32 v18, v18, v20
v_cvt_pk_bf16_f32 v20, v20, v20
v_add_f32 v18, v18, v21
v_cvt_pk_bf16_f32 v21, v21, v21
v_add_f32 v18, v18, v22
v_cvt_pk_bf16_f32 v22, v22, v22
v_add_f32 v18, v18, v23
v_cvt_pk_bf16_f32 v23, v23, v23
v_and_b32 v24, v20, v4
v_and_b32 v25, v20, v5
v_and_b32 v26, v20, v6
v_and_b32 v27, v20, v7
v_and_b32 v28, v21, v4
v_and_b32 v29, v21, v5
v_and_b32 v30, v21, v6
v_and_b32 v31, v21, v7
v_and_b32 v32, v22, v4
v_and_b32 v33, v22, v5
v_and_b32 v34, v22, v6
v_and_b32 v35, v22, v7
v_and_b32 v36, v23, v4
v_and_b32 v37, v23, v5
v_and_b32 v38, v23, v6
v_and_b32 v39, v23, v7
s_waitcnt vmcnt(28)
s_nop 0
v_mfma_f32_16x16x32_bf16 v[12:15], v[24:27], v[96:99], v[12:15]
v_mfma_f32_16x16x32_bf16 v[12:15], v[28:31], v[100:103], v[12:15]
v_mfma_f32_16x16x32_bf16 v[12:15], v[32:35], v[104:107], v[12:15]
v_mfma_f32_16x16x32_bf16 v[12:15], v[36:39], v[108:111], v[12:15]
s_waitcnt vmcnt(4)
buffer_load_dwordx4 v[96:99], v228, s[32:35], s61 offen nt
s_waitcnt vmcnt(4)
buffer_load_dwordx4 v[100:103], v229, s[32:35], s61 offen nt
s_waitcnt vmcnt(4)
buffer_load_dwordx4 v[104:107], v230, s[32:35], s61 offen nt
s_waitcnt vmcnt(5)
buffer_load_dwordx4 v[108:111], v231, s[32:35], s61 offen nt
s_waitcnt lgkmcnt(0)
v_fma_f32 v20, v246, s67, -v17
v_fma_f32 v21, v247, s67, -v17
v_fma_f32 v22, v248, s67, -v17
v_fma_f32 v23, v249, s67, -v17
v_exp_f32 v20, v20
v_exp_f32 v21, v21
v_exp_f32 v22, v22
v_exp_f32 v23, v23
v_add_f32 v18, v18, v20
v_cvt_pk_bf16_f32 v20, v20, v20
v_add_f32 v18, v18, v21
v_cvt_pk_bf16_f32 v21, v21, v21
v_add_f32 v18, v18, v22
v_cvt_pk_bf16_f32 v22, v22, v22
v_add_f32 v18, v18, v23
v_cvt_pk_bf16_f32 v23, v23, v23
v_and_b32 v24, v20, v4
v_and_b32 v25, v20, v5
v_and_b32 v26, v20, v6
v_and_b32 v27, v20, v7
v_and_b32 v28, v21, v4
v_and_b32 v29, v21, v5
v_and_b32 v30, v21, v6
v_and_b32 v31, v21, v7
v_and_b32 v32, v22, v4
v_and_b32 v33, v22, v5
v_and_b32 v34, v22, v6
v_and_b32 v35, v22, v7
v_and_b32 v36, v23, v4
v_and_b32 v37, v23, v5
v_and_b32 v38, v23, v6
v_and_b32 v39, v23, v7
s_waitcnt vmcnt(28)
s_nop 0
v_mfma_f32_16x16x32_bf16 v[12:15], v[24:27], v[112:115], v[12:15]
v_mfma_f32_16x16x32_bf16 v[12:15], v[28:31], v[116:119], v[12:15]
v_mfma_f32_16x16x32_bf16 v[12:15], v[32:35], v[120:123], v[12:15]
v_mfma_f32_16x16x32_bf16 v[12:15], v[36:39], v[124:127], v[12:15]
s_waitcnt vmcnt(4)
buffer_load_dwordx4 v[112:115], v232, s[36:39], s61 offen nt
s_waitcnt vmcnt(4)
buffer_load_dwordx4 v[116:119], v233, s[36:39], s61 offen nt
s_waitcnt vmcnt(4)
buffer_load_dwordx4 v[120:123], v234, s[36:39], s61 offen nt
s_waitcnt vmcnt(5)
buffer_load_dwordx4 v[124:127], v235, s[36:39], s61 offen nt
s_add_u32 s61, s61, s76
ds_read_b128 v[8:11], v244 offset:256
ds_read_b128 v[246:249], v244 offset:384
s_waitcnt lgkmcnt(1)
v_fma_f32 v20, v8, s67, -v17
v_fma_f32 v21, v9, s67, -v17
v_fma_f32 v22, v10, s67, -v17
v_fma_f32 v23, v11, s67, -v17
v_exp_f32 v20, v20
v_exp_f32 v21, v21
v_exp_f32 v22, v22
v_exp_f32 v23, v23
v_add_f32 v18, v18, v20
v_cvt_pk_bf16_f32 v20, v20, v20
v_add_f32 v18, v18, v21
v_cvt_pk_bf16_f32 v21, v21, v21
v_add_f32 v18, v18, v22
v_cvt_pk_bf16_f32 v22, v22, v22
v_add_f32 v18, v18, v23
v_cvt_pk_bf16_f32 v23, v23, v23
v_and_b32 v24, v20, v4
v_and_b32 v25, v20, v5
v_and_b32 v26, v20, v6
v_and_b32 v27, v20, v7
v_and_b32 v28, v21, v4
v_and_b32 v29, v21, v5
v_and_b32 v30, v21, v6
v_and_b32 v31, v21, v7
v_and_b32 v32, v22, v4
v_and_b32 v33, v22, v5
v_and_b32 v34, v22, v6
v_and_b32 v35, v22, v7
v_and_b32 v36, v23, v4
v_and_b32 v37, v23, v5
v_and_b32 v38, v23, v6
v_and_b32 v39, v23, v7
s_waitcnt vmcnt(28)
s_nop 0
v_mfma_f32_16x16x32_bf16 v[12:15], v[24:27], v[128:131], v[12:15]
v_mfma_f32_16x16x32_bf16 v[12:15], v[28:31], v[132:135], v[12:15]
v_mfma_f32_16x16x32_bf16 v[12:15], v[32:35], v[136:139], v[12:15]
v_mfma_f32_16x16x32_bf16 v[12:15], v[36:39], v[140:143], v[12:15]
s_waitcnt vmcnt(4)
buffer_load_dwordx4 v[128:131], v228, s[32:35], s61 offen nt
s_waitcnt vmcnt(4)
buffer_load_dwordx4 v[132:135], v229, s[32:35], s61 offen nt
s_waitcnt vmcnt(4)
buffer_load_dwordx4 v[136:139], v230, s[32:35], s61 offen nt
s_waitcnt vmcnt(5)
buffer_load_dwordx4 v[140:143], v231, s[32:35], s61 offen nt
s_waitcnt lgkmcnt(0)
v_fma_f32 v20, v246, s67, -v17
v_fma_f32 v21, v247, s67, -v17
v_fma_f32 v22, v248, s67, -v17
v_fma_f32 v23, v249, s67, -v17
v_exp_f32 v20, v20
v_exp_f32 v21, v21
v_exp_f32 v22, v22
v_exp_f32 v23, v23
v_add_f32 v18, v18, v20
v_cvt_pk_bf16_f32 v20, v20, v20
v_add_f32 v18, v18, v21
v_cvt_pk_bf16_f32 v21, v21, v21
v_add_f32 v18, v18, v22
v_cvt_pk_bf16_f32 v22, v22, v22
v_add_f32 v18, v18, v23
v_cvt_pk_bf16_f32 v23, v23, v23
v_and_b32 v24, v20, v4
v_and_b32 v25, v20, v5
v_and_b32 v26, v20, v6
v_and_b32 v27, v20, v7
v_and_b32 v28, v21, v4
v_and_b32 v29, v21, v5
v_and_b32 v30, v21, v6
v_and_b32 v31, v21, v7
v_and_b32 v32, v22, v4
v_and_b32 v33, v22, v5
v_and_b32 v34, v22, v6
v_and_b32 v35, v22, v7
v_and_b32 v36, v23, v4
v_and_b32 v37, v23, v5
v_and_b32 v38, v23, v6
v_and_b32 v39, v23, v7
s_waitcnt vmcnt(28)
s_nop 0
v_mfma_f32_16x16x32_bf16 v[12:15], v[24:27], v[144:147], v[12:15]
v_mfma_f32_16x16x32_bf16 v[12:15], v[28:31], v[148:151], v[12:15]
v_mfma_f32_16x16x32_bf16 v[12:15], v[32:35], v[152:155], v[12:15]
v_mfma_f32_16x16x32_bf16 v[12:15], v[36:39], v[156:159], v[12:15]
s_waitcnt vmcnt(4)
buffer_load_dwordx4 v[144:147], v232, s[36:39], s61 offen nt
s_waitcnt vmcnt(4)
buffer_load_dwordx4 v[148:151], v233, s[36:39], s61 offen nt
s_waitcnt vmcnt(4)
buffer_load_dwordx4 v[152:155], v234, s[36:39], s61 offen nt
s_waitcnt vmcnt(5)
buffer_load_dwordx4 v[156:159], v235, s[36:39], s61 offen nt
s_add_u32 s61, s61, s76
ds_read_b128 v[8:11], v244 offset:512
ds_read_b128 v[246:249], v244 offset:640
s_waitcnt lgkmcnt(1)
v_fma_f32 v20, v8, s67, -v17
v_fma_f32 v21, v9, s67, -v17
v_fma_f32 v22, v10, s67, -v17
v_fma_f32 v23, v11, s67, -v17
v_exp_f32 v20, v20
v_exp_f32 v21, v21
v_exp_f32 v22, v22
v_exp_f32 v23, v23
v_add_f32 v18, v18, v20
v_cvt_pk_bf16_f32 v20, v20, v20
v_add_f32 v18, v18, v21
v_cvt_pk_bf16_f32 v21, v21, v21
v_add_f32 v18, v18, v22
v_cvt_pk_bf16_f32 v22, v22, v22
v_add_f32 v18, v18, v23
v_cvt_pk_bf16_f32 v23, v23, v23
v_and_b32 v24, v20, v4
v_and_b32 v25, v20, v5
v_and_b32 v26, v20, v6
v_and_b32 v27, v20, v7
v_and_b32 v28, v21, v4
v_and_b32 v29, v21, v5
v_and_b32 v30, v21, v6
v_and_b32 v31, v21, v7
v_and_b32 v32, v22, v4
v_and_b32 v33, v22, v5
v_and_b32 v34, v22, v6
v_and_b32 v35, v22, v7
v_and_b32 v36, v23, v4
v_and_b32 v37, v23, v5
v_and_b32 v38, v23, v6
v_and_b32 v39, v23, v7
s_waitcnt vmcnt(28)
s_nop 0
v_mfma_f32_16x16x32_bf16 v[12:15], v[24:27], v[160:163], v[12:15]
v_mfma_f32_16x16x32_bf16 v[12:15], v[28:31], v[164:167], v[12:15]
v_mfma_f32_16x16x32_bf16 v[12:15], v[32:35], v[168:171], v[12:15]
v_mfma_f32_16x16x32_bf16 v[12:15], v[36:39], v[172:175], v[12:15]
s_waitcnt vmcnt(4)
buffer_load_dwordx4 v[160:163], v228, s[32:35], s61 offen nt
s_waitcnt vmcnt(4)
buffer_load_dwordx4 v[164:167], v229, s[32:35], s61 offen nt
s_waitcnt vmcnt(4)
buffer_load_dwordx4 v[168:171], v230, s[32:35], s61 offen nt
s_waitcnt vmcnt(5)
buffer_load_dwordx4 v[172:175], v231, s[32:35], s61 offen nt
s_waitcnt lgkmcnt(0)
v_fma_f32 v20, v246, s67, -v17
v_fma_f32 v21, v247, s67, -v17
v_fma_f32 v22, v248, s67, -v17
v_fma_f32 v23, v249, s67, -v17
v_exp_f32 v20, v20
v_exp_f32 v21, v21
v_exp_f32 v22, v22
v_exp_f32 v23, v23
v_add_f32 v18, v18, v20
v_cvt_pk_bf16_f32 v20, v20, v20
v_add_f32 v18, v18, v21
v_cvt_pk_bf16_f32 v21, v21, v21
v_add_f32 v18, v18, v22
v_cvt_pk_bf16_f32 v22, v22, v22
v_add_f32 v18, v18, v23
v_cvt_pk_bf16_f32 v23, v23, v23
v_and_b32 v24, v20, v4
v_and_b32 v25, v20, v5
v_and_b32 v26, v20, v6
v_and_b32 v27, v20, v7
v_and_b32 v28, v21, v4
v_and_b32 v29, v21, v5
v_and_b32 v30, v21, v6
v_and_b32 v31, v21, v7
v_and_b32 v32, v22, v4
v_and_b32 v33, v22, v5
v_and_b32 v34, v22, v6
v_and_b32 v35, v22, v7
v_and_b32 v36, v23, v4
v_and_b32 v37, v23, v5
v_and_b32 v38, v23, v6
v_and_b32 v39, v23, v7
s_waitcnt vmcnt(28)
s_nop 0
v_mfma_f32_16x16x32_bf16 v[12:15], v[24:27], v[176:179], v[12:15]
v_mfma_f32_16x16x32_bf16 v[12:15], v[28:31], v[180:183], v[12:15]
v_mfma_f32_16x16x32_bf16 v[12:15], v[32:35], v[184:187], v[12:15]
v_mfma_f32_16x16x32_bf16 v[12:15], v[36:39], v[188:191], v[12:15]
s_waitcnt vmcnt(4)
buffer_load_dwordx4 v[176:179], v232, s[36:39], s61 offen nt
s_waitcnt vmcnt(4)
buffer_load_dwordx4 v[180:183], v233, s[36:39], s61 offen nt
s_waitcnt vmcnt(4)
buffer_load_dwordx4 v[184:187], v234, s[36:39], s61 offen nt
s_waitcnt vmcnt(5)
buffer_load_dwordx4 v[188:191], v235, s[36:39], s61 offen nt
s_add_u32 s61, s61, s76
ds_read_b128 v[8:11], v244 offset:768
ds_read_b128 v[246:249], v244 offset:896
s_waitcnt lgkmcnt(1)
v_fma_f32 v20, v8, s67, -v17
v_fma_f32 v21, v9, s67, -v17
v_fma_f32 v22, v10, s67, -v17
v_fma_f32 v23, v11, s67, -v17
v_exp_f32 v20, v20
v_exp_f32 v21, v21
v_exp_f32 v22, v22
v_exp_f32 v23, v23
v_add_f32 v18, v18, v20
v_cvt_pk_bf16_f32 v20, v20, v20
v_add_f32 v18, v18, v21
v_cvt_pk_bf16_f32 v21, v21, v21
v_add_f32 v18, v18, v22
v_cvt_pk_bf16_f32 v22, v22, v22
v_add_f32 v18, v18, v23
v_cvt_pk_bf16_f32 v23, v23, v23
v_and_b32 v24, v20, v4
v_and_b32 v25, v20, v5
v_and_b32 v26, v20, v6
v_and_b32 v27, v20, v7
v_and_b32 v28, v21, v4
v_and_b32 v29, v21, v5
v_and_b32 v30, v21, v6
v_and_b32 v31, v21, v7
v_and_b32 v32, v22, v4
v_and_b32 v33, v22, v5
v_and_b32 v34, v22, v6
v_and_b32 v35, v22, v7
v_and_b32 v36, v23, v4
v_and_b32 v37, v23, v5
v_and_b32 v38, v23, v6
v_and_b32 v39, v23, v7
s_waitcnt vmcnt(28)
s_nop 0
v_mfma_f32_16x16x32_bf16 v[12:15], v[24:27], v[192:195], v[12:15]
v_mfma_f32_16x16x32_bf16 v[12:15], v[28:31], v[196:199], v[12:15]
v_mfma_f32_16x16x32_bf16 v[12:15], v[32:35], v[200:203], v[12:15]
v_mfma_f32_16x16x32_bf16 v[12:15], v[36:39], v[204:207], v[12:15]
s_waitcnt vmcnt(4)
buffer_load_dwordx4 v[192:195], v228, s[32:35], s61 offen nt
s_waitcnt vmcnt(4)
buffer_load_dwordx4 v[196:199], v229, s[32:35], s61 offen nt
s_waitcnt vmcnt(4)
buffer_load_dwordx4 v[200:203], v230, s[32:35], s61 offen nt
s_waitcnt vmcnt(5)
buffer_load_dwordx4 v[204:207], v231, s[32:35], s61 offen nt
s_waitcnt lgkmcnt(0)
v_fma_f32 v20, v246, s67, -v17
v_fma_f32 v21, v247, s67, -v17
v_fma_f32 v22, v248, s67, -v17
v_fma_f32 v23, v249, s67, -v17
v_exp_f32 v20, v20
v_exp_f32 v21, v21
v_exp_f32 v22, v22
v_exp_f32 v23, v23
v_add_f32 v18, v18, v20
v_cvt_pk_bf16_f32 v20, v20, v20
v_add_f32 v18, v18, v21
v_cvt_pk_bf16_f32 v21, v21, v21
v_add_f32 v18, v18, v22
v_cvt_pk_bf16_f32 v22, v22, v22
v_add_f32 v18, v18, v23
v_cvt_pk_bf16_f32 v23, v23, v23
v_and_b32 v24, v20, v4
v_and_b32 v25, v20, v5
v_and_b32 v26, v20, v6
v_and_b32 v27, v20, v7
v_and_b32 v28, v21, v4
v_and_b32 v29, v21, v5
v_and_b32 v30, v21, v6
v_and_b32 v31, v21, v7
v_and_b32 v32, v22, v4
v_and_b32 v33, v22, v5
v_and_b32 v34, v22, v6
v_and_b32 v35, v22, v7
v_and_b32 v36, v23, v4
v_and_b32 v37, v23, v5
v_and_b32 v38, v23, v6
v_and_b32 v39, v23, v7
s_waitcnt vmcnt(28)
s_nop 0
v_mfma_f32_16x16x32_bf16 v[12:15], v[24:27], v[208:211], v[12:15]
v_mfma_f32_16x16x32_bf16 v[12:15], v[28:31], v[212:215], v[12:15]
v_mfma_f32_16x16x32_bf16 v[12:15], v[32:35], v[216:219], v[12:15]
v_mfma_f32_16x16x32_bf16 v[12:15], v[36:39], v[220:223], v[12:15]
s_waitcnt vmcnt(4)
buffer_load_dwordx4 v[208:211], v232, s[36:39], s61 offen nt
s_waitcnt vmcnt(4)
buffer_load_dwordx4 v[212:215], v233, s[36:39], s61 offen nt
s_waitcnt vmcnt(4)
buffer_load_dwordx4 v[216:219], v234, s[36:39], s61 offen nt
s_waitcnt vmcnt(5)
buffer_load_dwordx4 v[220:223], v235, s[36:39], s61 offen nt
s_add_u32 s61, s61, s76
v_add_u32 v244, 1024, v244
s_sub_u32 s63, s63, 1
s_cmp_lg_u32 s63, 0
s_cbranch_scc1 L_pl_17
v_mov_b32 v19, v18
s_nop 1
v_permlane32_swap_b32 v18, v19
v_add_f32 v18, v18, v19
v_mov_b32 v19, v18
s_nop 1
v_permlane16_swap_b32 v18, v19
v_add_f32 v18, v18, v19
s_mul_i32 s65, s30, 1040
s_add_u32 s65, s65, 4160
v_lshrrev_b32 v19, 5, v0
v_lshlrev_b32 v19, 9, v19
v_and_b32 v20, 15, v0
v_lshl_add_u32 v19, v20, 5, v19
v_bfe_u32 v20, v0, 4, 1
v_lshl_add_u32 v19, v20, 4, v19
v_add_u32 v19, s65, v19
v_bfe_u32 v20, v0, 3, 1
v_lshl_add_u32 v20, v20, 3, s65
v_mov_b32 v22, v17
v_mov_b32 v23, v18
ds_write_b128 v19, v[12:15] offset:3072
ds_write_b64 v20, v[22:23] offset:4096
s_waitcnt lgkmcnt(0)
v_mov_b32 v16, v227
v_mul_f32 v17, s67, v227
v_mov_b32 v18, 0
v_mov_b32 v12, 0
v_mov_b32 v13, 0
v_mov_b32 v14, 0
v_mov_b32 v15, 0
s_lshl_b32 s65, s30, 13
s_add_u32 s65, s65, 26944
v_lshrrev_b32 v19, 4, v0
v_lshl_add_u32 v244, v19, 4, s65
s_barrier
s_mov_b32 s63, 5
L_pl_19:
ds_read_b128 v[8:11], v244 offset:0
ds_read_b128 v[246:249], v244 offset:128
s_waitcnt lgkmcnt(1)
v_fma_f32 v20, v8, s67, -v17
v_fma_f32 v21, v9, s67, -v17
v_fma_f32 v22, v10, s67, -v17
v_fma_f32 v23, v11, s67, -v17
v_exp_f32 v20, v20
v_exp_f32 v21, v21
v_exp_f32 v22, v22
v_exp_f32 v23, v23
v_add_f32 v18, v18, v20
v_cvt_pk_bf16_f32 v20, v20, v20
v_add_f32 v18, v18, v21
v_cvt_pk_bf16_f32 v21, v21, v21
v_add_f32 v18, v18, v22
v_cvt_pk_bf16_f32 v22, v22, v22
v_add_f32 v18, v18, v23
v_cvt_pk_bf16_f32 v23, v23, v23
v_and_b32 v24, v20, v4
v_and_b32 v25, v20, v5
v_and_b32 v26, v20, v6
v_and_b32 v27, v20, v7
v_and_b32 v28, v21, v4
v_and_b32 v29, v21, v5
v_and_b32 v30, v21, v6
v_and_b32 v31, v21, v7
v_and_b32 v32, v22, v4
v_and_b32 v33, v22, v5
v_and_b32 v34, v22, v6
v_and_b32 v35, v22, v7
v_and_b32 v36, v23, v4
v_and_b32 v37, v23, v5
v_and_b32 v38, v23, v6
v_and_b32 v39, v23, v7
s_waitcnt vmcnt(28)
s_nop 0
v_mfma_f32_16x16x32_bf16 v[12:15], v[24:27], v[96:99], v[12:15]
v_mfma_f32_16x16x32_bf16 v[12:15], v[28:31], v[100:103], v[12:15]
v_mfma_f32_16x16x32_bf16 v[12:15], v[32:35], v[104:107], v[12:15]
v_mfma_f32_16x16x32_bf16 v[12:15], v[36:39], v[108:111], v[12:15]
s_waitcnt vmcnt(4)
buffer_load_dwordx4 v[96:99], v228, s[32:35], s61 offen nt
s_waitcnt vmcnt(4)
buffer_load_dwordx4 v[100:103], v229, s[32:35], s61 offen nt
s_waitcnt vmcnt(4)
buffer_load_dwordx4 v[104:107], v230, s[32:35], s61 offen nt
s_waitcnt vmcnt(5)
buffer_load_dwordx4 v[108:111], v231, s[32:35], s61 offen nt
s_waitcnt lgkmcnt(0)
v_fma_f32 v20, v246, s67, -v17
v_fma_f32 v21, v247, s67, -v17
v_fma_f32 v22, v248, s67, -v17
v_fma_f32 v23, v249, s67, -v17
v_exp_f32 v20, v20
v_exp_f32 v21, v21
v_exp_f32 v22, v22
v_exp_f32 v23, v23
v_add_f32 v18, v18, v20
v_cvt_pk_bf16_f32 v20, v20, v20
v_add_f32 v18, v18, v21
v_cvt_pk_bf16_f32 v21, v21, v21
v_add_f32 v18, v18, v22
v_cvt_pk_bf16_f32 v22, v22, v22
v_add_f32 v18, v18, v23
v_cvt_pk_bf16_f32 v23, v23, v23
v_and_b32 v24, v20, v4
v_and_b32 v25, v20, v5
v_and_b32 v26, v20, v6
v_and_b32 v27, v20, v7
v_and_b32 v28, v21, v4
v_and_b32 v29, v21, v5
v_and_b32 v30, v21, v6
v_and_b32 v31, v21, v7
v_and_b32 v32, v22, v4
v_and_b32 v33, v22, v5
v_and_b32 v34, v22, v6
v_and_b32 v35, v22, v7
v_and_b32 v36, v23, v4
v_and_b32 v37, v23, v5
v_and_b32 v38, v23, v6
v_and_b32 v39, v23, v7
s_waitcnt vmcnt(28)
s_nop 0
v_mfma_f32_16x16x32_bf16 v[12:15], v[24:27], v[112:115], v[12:15]
v_mfma_f32_16x16x32_bf16 v[12:15], v[28:31], v[116:119], v[12:15]
v_mfma_f32_16x16x32_bf16 v[12:15], v[32:35], v[120:123], v[12:15]
v_mfma_f32_16x16x32_bf16 v[12:15], v[36:39], v[124:127], v[12:15]
s_waitcnt vmcnt(4)
buffer_load_dwordx4 v[112:115], v232, s[36:39], s61 offen nt
s_waitcnt vmcnt(4)
buffer_load_dwordx4 v[116:119], v233, s[36:39], s61 offen nt
s_waitcnt vmcnt(4)
buffer_load_dwordx4 v[120:123], v234, s[36:39], s61 offen nt
s_waitcnt vmcnt(5)
buffer_load_dwordx4 v[124:127], v235, s[36:39], s61 offen nt
s_add_u32 s61, s61, s76
ds_read_b128 v[8:11], v244 offset:256
ds_read_b128 v[246:249], v244 offset:384
s_waitcnt lgkmcnt(1)
v_fma_f32 v20, v8, s67, -v17
v_fma_f32 v21, v9, s67, -v17
v_fma_f32 v22, v10, s67, -v17
v_fma_f32 v23, v11, s67, -v17
v_exp_f32 v20, v20
v_exp_f32 v21, v21
v_exp_f32 v22, v22
v_exp_f32 v23, v23
v_add_f32 v18, v18, v20
v_cvt_pk_bf16_f32 v20, v20, v20
v_add_f32 v18, v18, v21
v_cvt_pk_bf16_f32 v21, v21, v21
v_add_f32 v18, v18, v22
v_cvt_pk_bf16_f32 v22, v22, v22
v_add_f32 v18, v18, v23
v_cvt_pk_bf16_f32 v23, v23, v23
v_and_b32 v24, v20, v4
v_and_b32 v25, v20, v5
v_and_b32 v26, v20, v6
v_and_b32 v27, v20, v7
v_and_b32 v28, v21, v4
v_and_b32 v29, v21, v5
v_and_b32 v30, v21, v6
v_and_b32 v31, v21, v7
v_and_b32 v32, v22, v4
v_and_b32 v33, v22, v5
v_and_b32 v34, v22, v6
v_and_b32 v35, v22, v7
v_and_b32 v36, v23, v4
v_and_b32 v37, v23, v5
v_and_b32 v38, v23, v6
v_and_b32 v39, v23, v7
s_waitcnt vmcnt(28)
s_nop 0
v_mfma_f32_16x16x32_bf16 v[12:15], v[24:27], v[128:131], v[12:15]
v_mfma_f32_16x16x32_bf16 v[12:15], v[28:31], v[132:135], v[12:15]
v_mfma_f32_16x16x32_bf16 v[12:15], v[32:35], v[136:139], v[12:15]
v_mfma_f32_16x16x32_bf16 v[12:15], v[36:39], v[140:143], v[12:15]
s_waitcnt vmcnt(4)
buffer_load_dwordx4 v[128:131], v228, s[32:35], s61 offen nt
s_waitcnt vmcnt(4)
buffer_load_dwordx4 v[132:135], v229, s[32:35], s61 offen nt
s_waitcnt vmcnt(4)
buffer_load_dwordx4 v[136:139], v230, s[32:35], s61 offen nt
s_waitcnt vmcnt(5)
buffer_load_dwordx4 v[140:143], v231, s[32:35], s61 offen nt
s_waitcnt lgkmcnt(0)
v_fma_f32 v20, v246, s67, -v17
v_fma_f32 v21, v247, s67, -v17
v_fma_f32 v22, v248, s67, -v17
v_fma_f32 v23, v249, s67, -v17
v_exp_f32 v20, v20
v_exp_f32 v21, v21
v_exp_f32 v22, v22
v_exp_f32 v23, v23
v_add_f32 v18, v18, v20
v_cvt_pk_bf16_f32 v20, v20, v20
v_add_f32 v18, v18, v21
v_cvt_pk_bf16_f32 v21, v21, v21
v_add_f32 v18, v18, v22
v_cvt_pk_bf16_f32 v22, v22, v22
v_add_f32 v18, v18, v23
v_cvt_pk_bf16_f32 v23, v23, v23
v_and_b32 v24, v20, v4
v_and_b32 v25, v20, v5
v_and_b32 v26, v20, v6
v_and_b32 v27, v20, v7
v_and_b32 v28, v21, v4
v_and_b32 v29, v21, v5
v_and_b32 v30, v21, v6
v_and_b32 v31, v21, v7
v_and_b32 v32, v22, v4
v_and_b32 v33, v22, v5
v_and_b32 v34, v22, v6
v_and_b32 v35, v22, v7
v_and_b32 v36, v23, v4
v_and_b32 v37, v23, v5
v_and_b32 v38, v23, v6
v_and_b32 v39, v23, v7
s_waitcnt vmcnt(28)
s_nop 0
v_mfma_f32_16x16x32_bf16 v[12:15], v[24:27], v[144:147], v[12:15]
v_mfma_f32_16x16x32_bf16 v[12:15], v[28:31], v[148:151], v[12:15]
v_mfma_f32_16x16x32_bf16 v[12:15], v[32:35], v[152:155], v[12:15]
v_mfma_f32_16x16x32_bf16 v[12:15], v[36:39], v[156:159], v[12:15]
s_waitcnt vmcnt(4)
buffer_load_dwordx4 v[144:147], v232, s[36:39], s61 offen nt
s_waitcnt vmcnt(4)
buffer_load_dwordx4 v[148:151], v233, s[36:39], s61 offen nt
s_waitcnt vmcnt(4)
buffer_load_dwordx4 v[152:155], v234, s[36:39], s61 offen nt
s_waitcnt vmcnt(5)
buffer_load_dwordx4 v[156:159], v235, s[36:39], s61 offen nt
s_add_u32 s61, s61, s76
ds_read_b128 v[8:11], v244 offset:512
ds_read_b128 v[246:249], v244 offset:640
s_waitcnt lgkmcnt(1)
v_fma_f32 v20, v8, s67, -v17
v_fma_f32 v21, v9, s67, -v17
v_fma_f32 v22, v10, s67, -v17
v_fma_f32 v23, v11, s67, -v17
v_exp_f32 v20, v20
v_exp_f32 v21, v21
v_exp_f32 v22, v22
v_exp_f32 v23, v23
v_add_f32 v18, v18, v20
v_cvt_pk_bf16_f32 v20, v20, v20
v_add_f32 v18, v18, v21
v_cvt_pk_bf16_f32 v21, v21, v21
v_add_f32 v18, v18, v22
v_cvt_pk_bf16_f32 v22, v22, v22
v_add_f32 v18, v18, v23
v_cvt_pk_bf16_f32 v23, v23, v23
v_and_b32 v24, v20, v4
v_and_b32 v25, v20, v5
v_and_b32 v26, v20, v6
v_and_b32 v27, v20, v7
v_and_b32 v28, v21, v4
v_and_b32 v29, v21, v5
v_and_b32 v30, v21, v6
v_and_b32 v31, v21, v7
v_and_b32 v32, v22, v4
v_and_b32 v33, v22, v5
v_and_b32 v34, v22, v6
v_and_b32 v35, v22, v7
v_and_b32 v36, v23, v4
v_and_b32 v37, v23, v5
v_and_b32 v38, v23, v6
v_and_b32 v39, v23, v7
s_waitcnt vmcnt(28)
s_nop 0
v_mfma_f32_16x16x32_bf16 v[12:15], v[24:27], v[160:163], v[12:15]
v_mfma_f32_16x16x32_bf16 v[12:15], v[28:31], v[164:167], v[12:15]
v_mfma_f32_16x16x32_bf16 v[12:15], v[32:35], v[168:171], v[12:15]
v_mfma_f32_16x16x32_bf16 v[12:15], v[36:39], v[172:175], v[12:15]
s_waitcnt vmcnt(4)
buffer_load_dwordx4 v[160:163], v228, s[32:35], s61 offen nt
s_waitcnt vmcnt(4)
buffer_load_dwordx4 v[164:167], v229, s[32:35], s61 offen nt
s_waitcnt vmcnt(4)
buffer_load_dwordx4 v[168:171], v230, s[32:35], s61 offen nt
s_waitcnt vmcnt(5)
buffer_load_dwordx4 v[172:175], v231, s[32:35], s61 offen nt
s_waitcnt lgkmcnt(0)
v_fma_f32 v20, v246, s67, -v17
v_fma_f32 v21, v247, s67, -v17
v_fma_f32 v22, v248, s67, -v17
v_fma_f32 v23, v249, s67, -v17
v_exp_f32 v20, v20
v_exp_f32 v21, v21
v_exp_f32 v22, v22
v_exp_f32 v23, v23
v_add_f32 v18, v18, v20
v_cvt_pk_bf16_f32 v20, v20, v20
v_add_f32 v18, v18, v21
v_cvt_pk_bf16_f32 v21, v21, v21
v_add_f32 v18, v18, v22
v_cvt_pk_bf16_f32 v22, v22, v22
v_add_f32 v18, v18, v23
v_cvt_pk_bf16_f32 v23, v23, v23
v_and_b32 v24, v20, v4
v_and_b32 v25, v20, v5
v_and_b32 v26, v20, v6
v_and_b32 v27, v20, v7
v_and_b32 v28, v21, v4
v_and_b32 v29, v21, v5
v_and_b32 v30, v21, v6
v_and_b32 v31, v21, v7
v_and_b32 v32, v22, v4
v_and_b32 v33, v22, v5
v_and_b32 v34, v22, v6
v_and_b32 v35, v22, v7
v_and_b32 v36, v23, v4
v_and_b32 v37, v23, v5
v_and_b32 v38, v23, v6
v_and_b32 v39, v23, v7
s_waitcnt vmcnt(28)
s_nop 0
v_mfma_f32_16x16x32_bf16 v[12:15], v[24:27], v[176:179], v[12:15]
v_mfma_f32_16x16x32_bf16 v[12:15], v[28:31], v[180:183], v[12:15]
v_mfma_f32_16x16x32_bf16 v[12:15], v[32:35], v[184:187], v[12:15]
v_mfma_f32_16x16x32_bf16 v[12:15], v[36:39], v[188:191], v[12:15]
s_waitcnt vmcnt(4)
buffer_load_dwordx4 v[176:179], v232, s[36:39], s61 offen nt
s_waitcnt vmcnt(4)
buffer_load_dwordx4 v[180:183], v233, s[36:39], s61 offen nt
s_waitcnt vmcnt(4)
buffer_load_dwordx4 v[184:187], v234, s[36:39], s61 offen nt
s_waitcnt vmcnt(5)
buffer_load_dwordx4 v[188:191], v235, s[36:39], s61 offen nt
s_add_u32 s61, s61, s76
ds_read_b128 v[8:11], v244 offset:768
ds_read_b128 v[246:249], v244 offset:896
s_waitcnt lgkmcnt(1)
v_fma_f32 v20, v8, s67, -v17
v_fma_f32 v21, v9, s67, -v17
v_fma_f32 v22, v10, s67, -v17
v_fma_f32 v23, v11, s67, -v17
v_exp_f32 v20, v20
v_exp_f32 v21, v21
v_exp_f32 v22, v22
v_exp_f32 v23, v23
v_add_f32 v18, v18, v20
v_cvt_pk_bf16_f32 v20, v20, v20
v_add_f32 v18, v18, v21
v_cvt_pk_bf16_f32 v21, v21, v21
v_add_f32 v18, v18, v22
v_cvt_pk_bf16_f32 v22, v22, v22
v_add_f32 v18, v18, v23
v_cvt_pk_bf16_f32 v23, v23, v23
v_and_b32 v24, v20, v4
v_and_b32 v25, v20, v5
v_and_b32 v26, v20, v6
v_and_b32 v27, v20, v7
v_and_b32 v28, v21, v4
v_and_b32 v29, v21, v5
v_and_b32 v30, v21, v6
v_and_b32 v31, v21, v7
v_and_b32 v32, v22, v4
v_and_b32 v33, v22, v5
v_and_b32 v34, v22, v6
v_and_b32 v35, v22, v7
v_and_b32 v36, v23, v4
v_and_b32 v37, v23, v5
v_and_b32 v38, v23, v6
v_and_b32 v39, v23, v7
s_waitcnt vmcnt(28)
s_nop 0
v_mfma_f32_16x16x32_bf16 v[12:15], v[24:27], v[192:195], v[12:15]
v_mfma_f32_16x16x32_bf16 v[12:15], v[28:31], v[196:199], v[12:15]
v_mfma_f32_16x16x32_bf16 v[12:15], v[32:35], v[200:203], v[12:15]
v_mfma_f32_16x16x32_bf16 v[12:15], v[36:39], v[204:207], v[12:15]
s_waitcnt vmcnt(4)
buffer_load_dwordx4 v[192:195], v228, s[32:35], s61 offen nt
s_waitcnt vmcnt(4)
buffer_load_dwordx4 v[196:199], v229, s[32:35], s61 offen nt
s_waitcnt vmcnt(4)
buffer_load_dwordx4 v[200:203], v230, s[32:35], s61 offen nt
s_waitcnt vmcnt(5)
buffer_load_dwordx4 v[204:207], v231, s[32:35], s61 offen nt
s_waitcnt lgkmcnt(0)
v_fma_f32 v20, v246, s67, -v17
v_fma_f32 v21, v247, s67, -v17
v_fma_f32 v22, v248, s67, -v17
v_fma_f32 v23, v249, s67, -v17
v_exp_f32 v20, v20
v_exp_f32 v21, v21
v_exp_f32 v22, v22
v_exp_f32 v23, v23
v_add_f32 v18, v18, v20
v_cvt_pk_bf16_f32 v20, v20, v20
v_add_f32 v18, v18, v21
v_cvt_pk_bf16_f32 v21, v21, v21
v_add_f32 v18, v18, v22
v_cvt_pk_bf16_f32 v22, v22, v22
v_add_f32 v18, v18, v23
v_cvt_pk_bf16_f32 v23, v23, v23
v_and_b32 v24, v20, v4
v_and_b32 v25, v20, v5
v_and_b32 v26, v20, v6
v_and_b32 v27, v20, v7
v_and_b32 v28, v21, v4
v_and_b32 v29, v21, v5
v_and_b32 v30, v21, v6
v_and_b32 v31, v21, v7
v_and_b32 v32, v22, v4
v_and_b32 v33, v22, v5
v_and_b32 v34, v22, v6
v_and_b32 v35, v22, v7
v_and_b32 v36, v23, v4
v_and_b32 v37, v23, v5
v_and_b32 v38, v23, v6
v_and_b32 v39, v23, v7
s_waitcnt vmcnt(28)
s_nop 0
v_mfma_f32_16x16x32_bf16 v[12:15], v[24:27], v[208:211], v[12:15]
v_mfma_f32_16x16x32_bf16 v[12:15], v[28:31], v[212:215], v[12:15]
v_mfma_f32_16x16x32_bf16 v[12:15], v[32:35], v[216:219], v[12:15]
v_mfma_f32_16x16x32_bf16 v[12:15], v[36:39], v[220:223], v[12:15]
s_waitcnt vmcnt(4)
buffer_load_dwordx4 v[208:211], v232, s[36:39], s61 offen nt
s_waitcnt vmcnt(4)
buffer_load_dwordx4 v[212:215], v233, s[36:39], s61 offen nt
s_waitcnt vmcnt(4)
buffer_load_dwordx4 v[216:219], v234, s[36:39], s61 offen nt
s_waitcnt vmcnt(5)
buffer_load_dwordx4 v[220:223], v235, s[36:39], s61 offen nt
s_add_u32 s61, s61, s76
v_add_u32 v244, 1024, v244
s_sub_u32 s63, s63, 1
s_cmp_lg_u32 s63, 0
s_cbranch_scc1 L_pl_19
s_lshl_b32 s81, s31, 2
s_add_u32 s81, s81, s30
s_lshl_b32 s81, s81, 8
s_add_u32 s81, s81, 3411968
s_lshl_b32 s89, s30, 12
s_add_u32 s89, s89, 917504
s_mov_b32 s80, 0x7fffffff
v_mov_b32 v225, 0
ds_read_b128 v[8:11], v244 offset:0
ds_read_b128 v[246:249], v244 offset:128
s_waitcnt lgkmcnt(1)
v_fma_f32 v20, v8, s67, -v17
v_fma_f32 v21, v9, s67, -v17
v_fma_f32 v22, v10, s67, -v17
v_fma_f32 v23, v11, s67, -v17
v_exp_f32 v20, v20
v_exp_f32 v21, v21
v_exp_f32 v22, v22
v_exp_f32 v23, v23
v_add_f32 v18, v18, v20
v_cvt_pk_bf16_f32 v20, v20, v20
v_add_f32 v18, v18, v21
v_cvt_pk_bf16_f32 v21, v21, v21
v_add_f32 v18, v18, v22
v_cvt_pk_bf16_f32 v22, v22, v22
v_add_f32 v18, v18, v23
v_cvt_pk_bf16_f32 v23, v23, v23
v_and_b32 v24, v20, v4
v_and_b32 v25, v20, v5
v_and_b32 v26, v20, v6
v_and_b32 v27, v20, v7
v_and_b32 v28, v21, v4
v_and_b32 v29, v21, v5
v_and_b32 v30, v21, v6
v_and_b32 v31, v21, v7
v_and_b32 v32, v22, v4
v_and_b32 v33, v22, v5
v_and_b32 v34, v22, v6
v_and_b32 v35, v22, v7
v_and_b32 v36, v23, v4
v_and_b32 v37, v23, v5
v_and_b32 v38, v23, v6
v_and_b32 v39, v23, v7
s_waitcnt vmcnt(28)
s_nop 0
v_mfma_f32_16x16x32_bf16 v[12:15], v[24:27], v[96:99], v[12:15]
v_mfma_f32_16x16x32_bf16 v[12:15], v[28:31], v[100:103], v[12:15]
v_mfma_f32_16x16x32_bf16 v[12:15], v[32:35], v[104:107], v[12:15]
v_mfma_f32_16x16x32_bf16 v[12:15], v[36:39], v[108:111], v[12:15]
s_waitcnt vmcnt(4)
buffer_load_dwordx4 v[96:99], v228, s[32:35], s61 offen nt
s_waitcnt vmcnt(4)
buffer_load_dwordx4 v[100:103], v229, s[32:35], s61 offen nt
s_waitcnt vmcnt(4)
buffer_load_dwordx4 v[104:107], v230, s[32:35], s61 offen nt
s_waitcnt vmcnt(5)
buffer_load_dwordx4 v[108:111], v231, s[32:35], s61 offen nt
s_waitcnt lgkmcnt(0)
v_fma_f32 v20, v246, s67, -v17
v_fma_f32 v21, v247, s67, -v17
v_fma_f32 v22, v248, s67, -v17
v_fma_f32 v23, v249, s67, -v17
v_exp_f32 v20, v20
v_exp_f32 v21, v21
v_exp_f32 v22, v22
v_exp_f32 v23, v23
v_add_f32 v18, v18, v20
v_cvt_pk_bf16_f32 v20, v20, v20
v_add_f32 v18, v18, v21
v_cvt_pk_bf16_f32 v21, v21, v21
v_add_f32 v18, v18, v22
v_cvt_pk_bf16_f32 v22, v22, v22
v_add_f32 v18, v18, v23
v_cvt_pk_bf16_f32 v23, v23, v23
v_and_b32 v24, v20, v4
v_and_b32 v25, v20, v5
v_and_b32 v26, v20, v6
v_and_b32 v27, v20, v7
v_and_b32 v28, v21, v4
v_and_b32 v29, v21, v5
v_and_b32 v30, v21, v6
v_and_b32 v31, v21, v7
v_and_b32 v32, v22, v4
v_and_b32 v33, v22, v5
v_and_b32 v34, v22, v6
v_and_b32 v35, v22, v7
v_and_b32 v36, v23, v4
v_and_b32 v37, v23, v5
v_and_b32 v38, v23, v6
v_and_b32 v39, v23, v7
s_waitcnt vmcnt(28)
s_nop 0
v_mfma_f32_16x16x32_bf16 v[12:15], v[24:27], v[112:115], v[12:15]
v_mfma_f32_16x16x32_bf16 v[12:15], v[28:31], v[116:119], v[12:15]
v_mfma_f32_16x16x32_bf16 v[12:15], v[32:35], v[120:123], v[12:15]
v_mfma_f32_16x16x32_bf16 v[12:15], v[36:39], v[124:127], v[12:15]
s_waitcnt vmcnt(4)
buffer_load_dwordx4 v[112:115], v232, s[36:39], s61 offen nt
s_waitcnt vmcnt(4)
buffer_load_dwordx4 v[116:119], v233, s[36:39], s61 offen nt
s_waitcnt vmcnt(4)
buffer_load_dwordx4 v[120:123], v234, s[36:39], s61 offen nt
s_waitcnt vmcnt(5)
buffer_load_dwordx4 v[124:127], v235, s[36:39], s61 offen nt
s_add_u32 s61, s61, s76
ds_read_b128 v[8:11], v244 offset:256
ds_read_b128 v[246:249], v244 offset:384
s_waitcnt lgkmcnt(1)
v_fma_f32 v20, v8, s67, -v17
v_fma_f32 v21, v9, s67, -v17
v_fma_f32 v22, v10, s67, -v17
v_fma_f32 v23, v11, s67, -v17
v_exp_f32 v20, v20
v_exp_f32 v21, v21
v_exp_f32 v22, v22
v_exp_f32 v23, v23
v_add_f32 v18, v18, v20
v_cvt_pk_bf16_f32 v20, v20, v20
v_add_f32 v18, v18, v21
v_cvt_pk_bf16_f32 v21, v21, v21
v_add_f32 v18, v18, v22
v_cvt_pk_bf16_f32 v22, v22, v22
v_add_f32 v18, v18, v23
v_cvt_pk_bf16_f32 v23, v23, v23
v_and_b32 v24, v20, v4
v_and_b32 v25, v20, v5
v_and_b32 v26, v20, v6
v_and_b32 v27, v20, v7
v_and_b32 v28, v21, v4
v_and_b32 v29, v21, v5
v_and_b32 v30, v21, v6
v_and_b32 v31, v21, v7
v_and_b32 v32, v22, v4
v_and_b32 v33, v22, v5
v_and_b32 v34, v22, v6
v_and_b32 v35, v22, v7
v_and_b32 v36, v23, v4
v_and_b32 v37, v23, v5
v_and_b32 v38, v23, v6
v_and_b32 v39, v23, v7
s_waitcnt vmcnt(28)
s_nop 0
v_mfma_f32_16x16x32_bf16 v[12:15], v[24:27], v[128:131], v[12:15]
v_mfma_f32_16x16x32_bf16 v[12:15], v[28:31], v[132:135], v[12:15]
v_mfma_f32_16x16x32_bf16 v[12:15], v[32:35], v[136:139], v[12:15]
v_mfma_f32_16x16x32_bf16 v[12:15], v[36:39], v[140:143], v[12:15]
s_waitcnt vmcnt(4)
buffer_load_dwordx4 v[128:131], v228, s[32:35], s61 offen nt
s_waitcnt vmcnt(4)
buffer_load_dwordx4 v[132:135], v229, s[32:35], s61 offen nt
s_waitcnt vmcnt(4)
buffer_load_dwordx4 v[136:139], v230, s[32:35], s61 offen nt
s_waitcnt vmcnt(5)
buffer_load_dwordx4 v[140:143], v231, s[32:35], s61 offen nt
s_waitcnt lgkmcnt(0)
v_fma_f32 v20, v246, s67, -v17
v_fma_f32 v21, v247, s67, -v17
v_fma_f32 v22, v248, s67, -v17
v_fma_f32 v23, v249, s67, -v17
v_exp_f32 v20, v20
v_exp_f32 v21, v21
v_exp_f32 v22, v22
v_exp_f32 v23, v23
v_add_f32 v18, v18, v20
v_cvt_pk_bf16_f32 v20, v20, v20
v_add_f32 v18, v18, v21
v_cvt_pk_bf16_f32 v21, v21, v21
v_add_f32 v18, v18, v22
v_cvt_pk_bf16_f32 v22, v22, v22
v_add_f32 v18, v18, v23
v_cvt_pk_bf16_f32 v23, v23, v23
v_and_b32 v24, v20, v4
v_and_b32 v25, v20, v5
v_and_b32 v26, v20, v6
v_and_b32 v27, v20, v7
v_and_b32 v28, v21, v4
v_and_b32 v29, v21, v5
v_and_b32 v30, v21, v6
v_and_b32 v31, v21, v7
v_and_b32 v32, v22, v4
v_and_b32 v33, v22, v5
v_and_b32 v34, v22, v6
v_and_b32 v35, v22, v7
v_and_b32 v36, v23, v4
v_and_b32 v37, v23, v5
v_and_b32 v38, v23, v6
v_and_b32 v39, v23, v7
s_waitcnt vmcnt(28)
s_nop 0
v_mfma_f32_16x16x32_bf16 v[12:15], v[24:27], v[144:147], v[12:15]
v_mfma_f32_16x16x32_bf16 v[12:15], v[28:31], v[148:151], v[12:15]
v_mfma_f32_16x16x32_bf16 v[12:15], v[32:35], v[152:155], v[12:15]
v_mfma_f32_16x16x32_bf16 v[12:15], v[36:39], v[156:159], v[12:15]
s_waitcnt vmcnt(4)
buffer_load_dwordx4 v[144:147], v232, s[36:39], s61 offen nt
s_waitcnt vmcnt(4)
buffer_load_dwordx4 v[148:151], v233, s[36:39], s61 offen nt
s_waitcnt vmcnt(4)
buffer_load_dwordx4 v[152:155], v234, s[36:39], s61 offen nt
s_waitcnt vmcnt(5)
buffer_load_dwordx4 v[156:159], v235, s[36:39], s61 offen nt
s_add_u32 s61, s61, s76
v_mov_b32 v224, 1
s_mov_b64 exec, 1
buffer_atomic_add v224, v225, s[40:43], s81 offen sc0 sc1
s_mov_b64 exec, -1
ds_read_b128 v[8:11], v244 offset:512
ds_read_b128 v[246:249], v244 offset:640
s_waitcnt lgkmcnt(1)
v_fma_f32 v20, v8, s67, -v17
v_fma_f32 v21, v9, s67, -v17
v_fma_f32 v22, v10, s67, -v17
v_fma_f32 v23, v11, s67, -v17
v_exp_f32 v20, v20
v_exp_f32 v21, v21
v_exp_f32 v22, v22
v_exp_f32 v23, v23
v_add_f32 v18, v18, v20
v_cvt_pk_bf16_f32 v20, v20, v20
v_add_f32 v18, v18, v21
v_cvt_pk_bf16_f32 v21, v21, v21
v_add_f32 v18, v18, v22
v_cvt_pk_bf16_f32 v22, v22, v22
v_add_f32 v18, v18, v23
v_cvt_pk_bf16_f32 v23, v23, v23
v_and_b32 v24, v20, v4
v_and_b32 v25, v20, v5
v_and_b32 v26, v20, v6
v_and_b32 v27, v20, v7
v_and_b32 v28, v21, v4
v_and_b32 v29, v21, v5
v_and_b32 v30, v21, v6
v_and_b32 v31, v21, v7
v_and_b32 v32, v22, v4
v_and_b32 v33, v22, v5
v_and_b32 v34, v22, v6
v_and_b32 v35, v22, v7
v_and_b32 v36, v23, v4
v_and_b32 v37, v23, v5
v_and_b32 v38, v23, v6
v_and_b32 v39, v23, v7
s_waitcnt vmcnt(28)
s_nop 0
v_mfma_f32_16x16x32_bf16 v[12:15], v[24:27], v[160:163], v[12:15]
v_mfma_f32_16x16x32_bf16 v[12:15], v[28:31], v[164:167], v[12:15]
v_mfma_f32_16x16x32_bf16 v[12:15], v[32:35], v[168:171], v[12:15]
v_mfma_f32_16x16x32_bf16 v[12:15], v[36:39], v[172:175], v[12:15]
s_waitcnt vmcnt(4)
buffer_load_dwordx4 v[160:163], v228, s[32:35], s61 offen nt
s_waitcnt vmcnt(4)
buffer_load_dwordx4 v[164:167], v229, s[32:35], s61 offen nt
s_waitcnt vmcnt(4)
buffer_load_dwordx4 v[168:171], v230, s[32:35], s61 offen nt
s_waitcnt vmcnt(5)
buffer_load_dwordx4 v[172:175], v231, s[32:35], s61 offen nt
s_waitcnt lgkmcnt(0)
v_fma_f32 v20, v246, s67, -v17
v_fma_f32 v21, v247, s67, -v17
v_fma_f32 v22, v248, s67, -v17
v_fma_f32 v23, v249, s67, -v17
v_exp_f32 v20, v20
v_exp_f32 v21, v21
v_exp_f32 v22, v22
v_exp_f32 v23, v23
v_add_f32 v18, v18, v20
v_cvt_pk_bf16_f32 v20, v20, v20
v_add_f32 v18, v18, v21
v_cvt_pk_bf16_f32 v21, v21, v21
v_add_f32 v18, v18, v22
v_cvt_pk_bf16_f32 v22, v22, v22
v_add_f32 v18, v18, v23
v_cvt_pk_bf16_f32 v23, v23, v23
v_and_b32 v24, v20, v4
v_and_b32 v25, v20, v5
v_and_b32 v26, v20, v6
v_and_b32 v27, v20, v7
v_and_b32 v28, v21, v4
v_and_b32 v29, v21, v5
v_and_b32 v30, v21, v6
v_and_b32 v31, v21, v7
v_and_b32 v32, v22, v4
v_and_b32 v33, v22, v5
v_and_b32 v34, v22, v6
v_and_b32 v35, v22, v7
v_and_b32 v36, v23, v4
v_and_b32 v37, v23, v5
v_and_b32 v38, v23, v6
v_and_b32 v39, v23, v7
s_waitcnt vmcnt(28)
s_nop 0
v_mfma_f32_16x16x32_bf16 v[12:15], v[24:27], v[176:179], v[12:15]
v_mfma_f32_16x16x32_bf16 v[12:15], v[28:31], v[180:183], v[12:15]
v_mfma_f32_16x16x32_bf16 v[12:15], v[32:35], v[184:187], v[12:15]
v_mfma_f32_16x16x32_bf16 v[12:15], v[36:39], v[188:191], v[12:15]
s_waitcnt vmcnt(4)
buffer_load_dwordx4 v[176:179], v232, s[36:39], s61 offen nt
s_waitcnt vmcnt(4)
buffer_load_dwordx4 v[180:183], v233, s[36:39], s61 offen nt
s_waitcnt vmcnt(4)
buffer_load_dwordx4 v[184:187], v234, s[36:39], s61 offen nt
s_waitcnt vmcnt(5)
buffer_load_dwordx4 v[188:191], v235, s[36:39], s61 offen nt
s_add_u32 s61, s61, s76
ds_read_b128 v[8:11], v244 offset:768
ds_read_b128 v[246:249], v244 offset:896
s_waitcnt lgkmcnt(1)
v_fma_f32 v20, v8, s67, -v17
v_fma_f32 v21, v9, s67, -v17
v_fma_f32 v22, v10, s67, -v17
v_fma_f32 v23, v11, s67, -v17
v_exp_f32 v20, v20
v_exp_f32 v21, v21
v_exp_f32 v22, v22
v_exp_f32 v23, v23
v_add_f32 v18, v18, v20
v_cvt_pk_bf16_f32 v20, v20, v20
v_add_f32 v18, v18, v21
v_cvt_pk_bf16_f32 v21, v21, v21
v_add_f32 v18, v18, v22
v_cvt_pk_bf16_f32 v22, v22, v22
v_add_f32 v18, v18, v23
v_cvt_pk_bf16_f32 v23, v23, v23
v_and_b32 v24, v20, v4
v_and_b32 v25, v20, v5
v_and_b32 v26, v20, v6
v_and_b32 v27, v20, v7
v_and_b32 v28, v21, v4
v_and_b32 v29, v21, v5
v_and_b32 v30, v21, v6
v_and_b32 v31, v21, v7
v_and_b32 v32, v22, v4
v_and_b32 v33, v22, v5
v_and_b32 v34, v22, v6
v_and_b32 v35, v22, v7
v_and_b32 v36, v23, v4
v_and_b32 v37, v23, v5
v_and_b32 v38, v23, v6
v_and_b32 v39, v23, v7
s_waitcnt vmcnt(28)
s_nop 0
v_mfma_f32_16x16x32_bf16 v[12:15], v[24:27], v[192:195], v[12:15]
v_mfma_f32_16x16x32_bf16 v[12:15], v[28:31], v[196:199], v[12:15]
v_mfma_f32_16x16x32_bf16 v[12:15], v[32:35], v[200:203], v[12:15]
v_mfma_f32_16x16x32_bf16 v[12:15], v[36:39], v[204:207], v[12:15]
s_waitcnt vmcnt(4)
buffer_load_dwordx4 v[192:195], v228, s[32:35], s61 offen nt
s_waitcnt vmcnt(4)
buffer_load_dwordx4 v[196:199], v229, s[32:35], s61 offen nt
s_waitcnt vmcnt(4)
buffer_load_dwordx4 v[200:203], v230, s[32:35], s61 offen nt
s_waitcnt vmcnt(5)
buffer_load_dwordx4 v[204:207], v231, s[32:35], s61 offen nt
s_waitcnt lgkmcnt(0)
v_fma_f32 v20, v246, s67, -v17
v_fma_f32 v21, v247, s67, -v17
v_fma_f32 v22, v248, s67, -v17
v_fma_f32 v23, v249, s67, -v17
v_exp_f32 v20, v20
v_exp_f32 v21, v21
v_exp_f32 v22, v22
v_exp_f32 v23, v23
v_add_f32 v18, v18, v20
v_cvt_pk_bf16_f32 v20, v20, v20
v_add_f32 v18, v18, v21
v_cvt_pk_bf16_f32 v21, v21, v21
v_add_f32 v18, v18, v22
v_cvt_pk_bf16_f32 v22, v22, v22
v_add_f32 v18, v18, v23
v_cvt_pk_bf16_f32 v23, v23, v23
v_and_b32 v24, v20, v4
v_and_b32 v25, v20, v5
v_and_b32 v26, v20, v6
v_and_b32 v27, v20, v7
v_and_b32 v28, v21, v4
v_and_b32 v29, v21, v5
v_and_b32 v30, v21, v6
v_and_b32 v31, v21, v7
v_and_b32 v32, v22, v4
v_and_b32 v33, v22, v5
v_and_b32 v34, v22, v6
v_and_b32 v35, v22, v7
v_and_b32 v36, v23, v4
v_and_b32 v37, v23, v5
v_and_b32 v38, v23, v6
v_and_b32 v39, v23, v7
s_waitcnt vmcnt(28)
s_nop 0
v_mfma_f32_16x16x32_bf16 v[12:15], v[24:27], v[208:211], v[12:15]
v_mfma_f32_16x16x32_bf16 v[12:15], v[28:31], v[212:215], v[12:15]
v_mfma_f32_16x16x32_bf16 v[12:15], v[32:35], v[216:219], v[12:15]
v_mfma_f32_16x16x32_bf16 v[12:15], v[36:39], v[220:223], v[12:15]
s_waitcnt vmcnt(4)
buffer_load_dwordx4 v[208:211], v232, s[36:39], s61 offen nt
s_waitcnt vmcnt(4)
buffer_load_dwordx4 v[212:215], v233, s[36:39], s61 offen nt
s_waitcnt vmcnt(4)
buffer_load_dwordx4 v[216:219], v234, s[36:39], s61 offen nt
s_waitcnt vmcnt(5)
buffer_load_dwordx4 v[220:223], v235, s[36:39], s61 offen nt
s_add_u32 s61, s61, s76
s_waitcnt vmcnt(16)
v_readfirstlane_b32 s77, v224
v_add_u32 v244, 1024, v244
s_mov_b32 s32, s56
s_mov_b32 s33, s57
s_mov_b32 s36, s58
s_mov_b32 s37, s59
s_add_u32 s61, s60, 0
s_mov_b32 s76, 16384
v_mov_b32 v228, v1
v_add_u32 v229, 64, v1
v_add_u32 v230, 128, v1
v_add_u32 v231, 192, v1
v_mov_b32 v232, v2
v_add_u32 v233, 1024, v2
v_add_u32 v234, 2048, v2
v_add_u32 v235, 3072, v2
s_cmp_lt_u32 s77, 64
s_cselect_b32 s34, 0x1000000, 0
s_cselect_b32 s65, s80, 0
s_mov_b32 s38, s34
s_min_u32 s80, s80, s65
s_lshr_b32 s65, s77, 4
s_and_b32 s65, s65, 31
s_lshl_b32 s65, s65, 15
s_add_u32 s61, s65, s89
s_and_b32 s65, s77, 15
s_lshl_b32 s65, s65, 20
s_add_u32 s61, s61, s65
v_mov_b32 v224, 1
s_mov_b64 exec, 1
buffer_atomic_add v224, v225, s[40:43], s81 offen sc0 sc1
s_mov_b64 exec, -1
ds_read_b128 v[8:11], v244 offset:0
ds_read_b128 v[246:249], v244 offset:128
s_waitcnt lgkmcnt(1)
v_fma_f32 v20, v8, s67, -v17
v_fma_f32 v21, v9, s67, -v17
v_fma_f32 v22, v10, s67, -v17
v_fma_f32 v23, v11, s67, -v17
v_exp_f32 v20, v20
v_exp_f32 v21, v21
v_exp_f32 v22, v22
v_exp_f32 v23, v23
v_add_f32 v18, v18, v20
v_cvt_pk_bf16_f32 v20, v20, v20
v_add_f32 v18, v18, v21
v_cvt_pk_bf16_f32 v21, v21, v21
v_add_f32 v18, v18, v22
v_cvt_pk_bf16_f32 v22, v22, v22
v_add_f32 v18, v18, v23
v_cvt_pk_bf16_f32 v23, v23, v23
v_and_b32 v24, v20, v4
v_and_b32 v25, v20, v5
v_and_b32 v26, v20, v6
v_and_b32 v27, v20, v7
v_and_b32 v28, v21, v4
v_and_b32 v29, v21, v5
v_and_b32 v30, v21, v6
v_and_b32 v31, v21, v7
v_and_b32 v32, v22, v4
v_and_b32 v33, v22, v5
v_and_b32 v34, v22, v6
v_and_b32 v35, v22, v7
v_and_b32 v36, v23, v4
v_and_b32 v37, v23, v5
v_and_b32 v38, v23, v6
v_and_b32 v39, v23, v7
s_waitcnt vmcnt(28)
s_nop 0
v_mfma_f32_16x16x32_bf16 v[12:15], v[24:27], v[96:99], v[12:15]
v_mfma_f32_16x16x32_bf16 v[12:15], v[28:31], v[100:103], v[12:15]
v_mfma_f32_16x16x32_bf16 v[12:15], v[32:35], v[104:107], v[12:15]
v_mfma_f32_16x16x32_bf16 v[12:15], v[36:39], v[108:111], v[12:15]
s_waitcnt vmcnt(4)
buffer_load_dwordx4 v[96:99], v228, s[32:35], s61 offen nt
s_waitcnt vmcnt(4)
buffer_load_dwordx4 v[100:103], v229, s[32:35], s61 offen nt
s_waitcnt vmcnt(4)
buffer_load_dwordx4 v[104:107], v230, s[32:35], s61 offen nt
s_waitcnt vmcnt(5)
buffer_load_dwordx4 v[108:111], v231, s[32:35], s61 offen nt
s_waitcnt lgkmcnt(0)
v_fma_f32 v20, v246, s67, -v17
v_fma_f32 v21, v247, s67, -v17
v_fma_f32 v22, v248, s67, -v17
v_fma_f32 v23, v249, s67, -v17
v_exp_f32 v20, v20
v_exp_f32 v21, v21
v_exp_f32 v22, v22
v_exp_f32 v23, v23
v_add_f32 v18, v18, v20
v_cvt_pk_bf16_f32 v20, v20, v20
v_add_f32 v18, v18, v21
v_cvt_pk_bf16_f32 v21, v21, v21
v_add_f32 v18, v18, v22
v_cvt_pk_bf16_f32 v22, v22, v22
v_add_f32 v18, v18, v23
v_cvt_pk_bf16_f32 v23, v23, v23
v_and_b32 v24, v20, v4
v_and_b32 v25, v20, v5
v_and_b32 v26, v20, v6
v_and_b32 v27, v20, v7
v_and_b32 v28, v21, v4
v_and_b32 v29, v21, v5
v_and_b32 v30, v21, v6
v_and_b32 v31, v21, v7
v_and_b32 v32, v22, v4
v_and_b32 v33, v22, v5
v_and_b32 v34, v22, v6
v_and_b32 v35, v22, v7
v_and_b32 v36, v23, v4
v_and_b32 v37, v23, v5
v_and_b32 v38, v23, v6
v_and_b32 v39, v23, v7
s_waitcnt vmcnt(28)
s_nop 0
v_mfma_f32_16x16x32_bf16 v[12:15], v[24:27], v[112:115], v[12:15]
v_mfma_f32_16x16x32_bf16 v[12:15], v[28:31], v[116:119], v[12:15]
v_mfma_f32_16x16x32_bf16 v[12:15], v[32:35], v[120:123], v[12:15]
v_mfma_f32_16x16x32_bf16 v[12:15], v[36:39], v[124:127], v[12:15]
s_waitcnt vmcnt(4)
buffer_load_dwordx4 v[112:115], v232, s[36:39], s61 offen nt
s_waitcnt vmcnt(4)
buffer_load_dwordx4 v[116:119], v233, s[36:39], s61 offen nt
s_waitcnt vmcnt(4)
buffer_load_dwordx4 v[120:123], v234, s[36:39], s61 offen nt
s_waitcnt vmcnt(5)
buffer_load_dwordx4 v[124:127], v235, s[36:39], s61 offen nt
s_add_u32 s61, s61, s76
ds_read_b128 v[8:11], v244 offset:256
ds_read_b128 v[246:249], v244 offset:384
s_waitcnt lgkmcnt(1)
v_fma_f32 v20, v8, s67, -v17
v_fma_f32 v21, v9, s67, -v17
v_fma_f32 v22, v10, s67, -v17
v_fma_f32 v23, v11, s67, -v17
v_exp_f32 v20, v20
v_exp_f32 v21, v21
v_exp_f32 v22, v22
v_exp_f32 v23, v23
v_add_f32 v18, v18, v20
v_cvt_pk_bf16_f32 v20, v20, v20
v_add_f32 v18, v18, v21
v_cvt_pk_bf16_f32 v21, v21, v21
v_add_f32 v18, v18, v22
v_cvt_pk_bf16_f32 v22, v22, v22
v_add_f32 v18, v18, v23
v_cvt_pk_bf16_f32 v23, v23, v23
v_and_b32 v24, v20, v4
v_and_b32 v25, v20, v5
v_and_b32 v26, v20, v6
v_and_b32 v27, v20, v7
v_and_b32 v28, v21, v4
v_and_b32 v29, v21, v5
v_and_b32 v30, v21, v6
v_and_b32 v31, v21, v7
v_and_b32 v32, v22, v4
v_and_b32 v33, v22, v5
v_and_b32 v34, v22, v6
v_and_b32 v35, v22, v7
v_and_b32 v36, v23, v4
v_and_b32 v37, v23, v5
v_and_b32 v38, v23, v6
v_and_b32 v39, v23, v7
s_waitcnt vmcnt(28)
s_nop 0
v_mfma_f32_16x16x32_bf16 v[12:15], v[24:27], v[128:131], v[12:15]
v_mfma_f32_16x16x32_bf16 v[12:15], v[28:31], v[132:135], v[12:15]
v_mfma_f32_16x16x32_bf16 v[12:15], v[32:35], v[136:139], v[12:15]
v_mfma_f32_16x16x32_bf16 v[12:15], v[36:39], v[140:143], v[12:15]
s_waitcnt vmcnt(4)
buffer_load_dwordx4 v[128:131], v228, s[32:35], s61 offen nt
s_waitcnt vmcnt(4)
buffer_load_dwordx4 v[132:135], v229, s[32:35], s61 offen nt
s_waitcnt vmcnt(4)
buffer_load_dwordx4 v[136:139], v230, s[32:35], s61 offen nt
s_waitcnt vmcnt(5)
buffer_load_dwordx4 v[140:143], v231, s[32:35], s61 offen nt
s_waitcnt lgkmcnt(0)
v_fma_f32 v20, v246, s67, -v17
v_fma_f32 v21, v247, s67, -v17
v_fma_f32 v22, v248, s67, -v17
v_fma_f32 v23, v249, s67, -v17
v_exp_f32 v20, v20
v_exp_f32 v21, v21
v_exp_f32 v22, v22
v_exp_f32 v23, v23
v_add_f32 v18, v18, v20
v_cvt_pk_bf16_f32 v20, v20, v20
v_add_f32 v18, v18, v21
v_cvt_pk_bf16_f32 v21, v21, v21
v_add_f32 v18, v18, v22
v_cvt_pk_bf16_f32 v22, v22, v22
v_add_f32 v18, v18, v23
v_cvt_pk_bf16_f32 v23, v23, v23
v_and_b32 v24, v20, v4
v_and_b32 v25, v20, v5
v_and_b32 v26, v20, v6
v_and_b32 v27, v20, v7
v_and_b32 v28, v21, v4
v_and_b32 v29, v21, v5
v_and_b32 v30, v21, v6
v_and_b32 v31, v21, v7
v_and_b32 v32, v22, v4
v_and_b32 v33, v22, v5
v_and_b32 v34, v22, v6
v_and_b32 v35, v22, v7
v_and_b32 v36, v23, v4
v_and_b32 v37, v23, v5
v_and_b32 v38, v23, v6
v_and_b32 v39, v23, v7
s_waitcnt vmcnt(28)
s_nop 0
v_mfma_f32_16x16x32_bf16 v[12:15], v[24:27], v[144:147], v[12:15]
v_mfma_f32_16x16x32_bf16 v[12:15], v[28:31], v[148:151], v[12:15]
v_mfma_f32_16x16x32_bf16 v[12:15], v[32:35], v[152:155], v[12:15]
v_mfma_f32_16x16x32_bf16 v[12:15], v[36:39], v[156:159], v[12:15]
s_waitcnt vmcnt(4)
buffer_load_dwordx4 v[144:147], v232, s[36:39], s61 offen nt
s_waitcnt vmcnt(4)
buffer_load_dwordx4 v[148:151], v233, s[36:39], s61 offen nt
s_waitcnt vmcnt(4)
buffer_load_dwordx4 v[152:155], v234, s[36:39], s61 offen nt
s_waitcnt vmcnt(5)
buffer_load_dwordx4 v[156:159], v235, s[36:39], s61 offen nt
s_add_u32 s61, s61, s76
s_waitcnt vmcnt(16)
v_readfirstlane_b32 s77, v224
s_cmp_lt_u32 s77, 64
s_cselect_b32 s34, 0x1000000, 0
s_cselect_b32 s65, s80, 1
s_mov_b32 s38, s34
s_min_u32 s80, s80, s65
s_lshr_b32 s65, s77, 4
s_and_b32 s65, s65, 31
s_lshl_b32 s65, s65, 15
s_add_u32 s61, s65, s89
s_and_b32 s65, s77, 15
s_lshl_b32 s65, s65, 20
s_add_u32 s61, s61, s65
v_mov_b32 v224, 1
s_mov_b64 exec, 1
buffer_atomic_add v224, v225, s[40:43], s81 offen sc0 sc1
s_mov_b64 exec, -1
ds_read_b128 v[8:11], v244 offset:512
ds_read_b128 v[246:249], v244 offset:640
s_waitcnt lgkmcnt(1)
v_fma_f32 v20, v8, s67, -v17
v_fma_f32 v21, v9, s67, -v17
v_fma_f32 v22, v10, s67, -v17
v_fma_f32 v23, v11, s67, -v17
v_exp_f32 v20, v20
v_exp_f32 v21, v21
v_exp_f32 v22, v22
v_exp_f32 v23, v23
v_add_f32 v18, v18, v20
v_cvt_pk_bf16_f32 v20, v20, v20
v_add_f32 v18, v18, v21
v_cvt_pk_bf16_f32 v21, v21, v21
v_add_f32 v18, v18, v22
v_cvt_pk_bf16_f32 v22, v22, v22
v_add_f32 v18, v18, v23
v_cvt_pk_bf16_f32 v23, v23, v23
v_and_b32 v24, v20, v4
v_and_b32 v25, v20, v5
v_and_b32 v26, v20, v6
v_and_b32 v27, v20, v7
v_and_b32 v28, v21, v4
v_and_b32 v29, v21, v5
v_and_b32 v30, v21, v6
v_and_b32 v31, v21, v7
v_and_b32 v32, v22, v4
v_and_b32 v33, v22, v5
v_and_b32 v34, v22, v6
v_and_b32 v35, v22, v7
v_and_b32 v36, v23, v4
v_and_b32 v37, v23, v5
v_and_b32 v38, v23, v6
v_and_b32 v39, v23, v7
s_waitcnt vmcnt(28)
s_nop 0
v_mfma_f32_16x16x32_bf16 v[12:15], v[24:27], v[160:163], v[12:15]
v_mfma_f32_16x16x32_bf16 v[12:15], v[28:31], v[164:167], v[12:15]
v_mfma_f32_16x16x32_bf16 v[12:15], v[32:35], v[168:171], v[12:15]
v_mfma_f32_16x16x32_bf16 v[12:15], v[36:39], v[172:175], v[12:15]
s_waitcnt vmcnt(4)
buffer_load_dwordx4 v[160:163], v228, s[32:35], s61 offen nt
s_waitcnt vmcnt(4)
buffer_load_dwordx4 v[164:167], v229, s[32:35], s61 offen nt
s_waitcnt vmcnt(4)
buffer_load_dwordx4 v[168:171], v230, s[32:35], s61 offen nt
s_waitcnt vmcnt(5)
buffer_load_dwordx4 v[172:175], v231, s[32:35], s61 offen nt
s_waitcnt lgkmcnt(0)
v_fma_f32 v20, v246, s67, -v17
v_fma_f32 v21, v247, s67, -v17
v_fma_f32 v22, v248, s67, -v17
v_fma_f32 v23, v249, s67, -v17
v_exp_f32 v20, v20
v_exp_f32 v21, v21
v_exp_f32 v22, v22
v_exp_f32 v23, v23
v_add_f32 v18, v18, v20
v_cvt_pk_bf16_f32 v20, v20, v20
v_add_f32 v18, v18, v21
v_cvt_pk_bf16_f32 v21, v21, v21
v_add_f32 v18, v18, v22
v_cvt_pk_bf16_f32 v22, v22, v22
v_add_f32 v18, v18, v23
v_cvt_pk_bf16_f32 v23, v23, v23
v_and_b32 v24, v20, v4
v_and_b32 v25, v20, v5
v_and_b32 v26, v20, v6
v_and_b32 v27, v20, v7
v_and_b32 v28, v21, v4
v_and_b32 v29, v21, v5
v_and_b32 v30, v21, v6
v_and_b32 v31, v21, v7
v_and_b32 v32, v22, v4
v_and_b32 v33, v22, v5
v_and_b32 v34, v22, v6
v_and_b32 v35, v22, v7
v_and_b32 v36, v23, v4
v_and_b32 v37, v23, v5
v_and_b32 v38, v23, v6
v_and_b32 v39, v23, v7
s_waitcnt vmcnt(28)
s_nop 0
v_mfma_f32_16x16x32_bf16 v[12:15], v[24:27], v[176:179], v[12:15]
v_mfma_f32_16x16x32_bf16 v[12:15], v[28:31], v[180:183], v[12:15]
v_mfma_f32_16x16x32_bf16 v[12:15], v[32:35], v[184:187], v[12:15]
v_mfma_f32_16x16x32_bf16 v[12:15], v[36:39], v[188:191], v[12:15]
s_waitcnt vmcnt(4)
buffer_load_dwordx4 v[176:179], v232, s[36:39], s61 offen nt
s_waitcnt vmcnt(4)
buffer_load_dwordx4 v[180:183], v233, s[36:39], s61 offen nt
s_waitcnt vmcnt(4)
buffer_load_dwordx4 v[184:187], v234, s[36:39], s61 offen nt
s_waitcnt vmcnt(5)
buffer_load_dwordx4 v[188:191], v235, s[36:39], s61 offen nt
s_add_u32 s61, s61, s76
ds_read_b128 v[8:11], v244 offset:768
ds_read_b128 v[246:249], v244 offset:896
s_waitcnt lgkmcnt(1)
v_fma_f32 v20, v8, s67, -v17
v_fma_f32 v21, v9, s67, -v17
v_fma_f32 v22, v10, s67, -v17
v_fma_f32 v23, v11, s67, -v17
v_exp_f32 v20, v20
v_exp_f32 v21, v21
v_exp_f32 v22, v22
v_exp_f32 v23, v23
v_add_f32 v18, v18, v20
v_cvt_pk_bf16_f32 v20, v20, v20
v_add_f32 v18, v18, v21
v_cvt_pk_bf16_f32 v21, v21, v21
v_add_f32 v18, v18, v22
v_cvt_pk_bf16_f32 v22, v22, v22
v_add_f32 v18, v18, v23
v_cvt_pk_bf16_f32 v23, v23, v23
v_and_b32 v24, v20, v4
v_and_b32 v25, v20, v5
v_and_b32 v26, v20, v6
v_and_b32 v27, v20, v7
v_and_b32 v28, v21, v4
v_and_b32 v29, v21, v5
v_and_b32 v30, v21, v6
v_and_b32 v31, v21, v7
v_and_b32 v32, v22, v4
v_and_b32 v33, v22, v5
v_and_b32 v34, v22, v6
v_and_b32 v35, v22, v7
v_and_b32 v36, v23, v4
v_and_b32 v37, v23, v5
v_and_b32 v38, v23, v6
v_and_b32 v39, v23, v7
s_waitcnt vmcnt(28)
s_nop 0
v_mfma_f32_16x16x32_bf16 v[12:15], v[24:27], v[192:195], v[12:15]
v_mfma_f32_16x16x32_bf16 v[12:15], v[28:31], v[196:199], v[12:15]
v_mfma_f32_16x16x32_bf16 v[12:15], v[32:35], v[200:203], v[12:15]
v_mfma_f32_16x16x32_bf16 v[12:15], v[36:39], v[204:207], v[12:15]
s_waitcnt vmcnt(4)
buffer_load_dwordx4 v[192:195], v228, s[32:35], s61 offen nt
s_waitcnt vmcnt(4)
buffer_load_dwordx4 v[196:199], v229, s[32:35], s61 offen nt
s_waitcnt vmcnt(4)
buffer_load_dwordx4 v[200:203], v230, s[32:35], s61 offen nt
s_waitcnt vmcnt(5)
buffer_load_dwordx4 v[204:207], v231, s[32:35], s61 offen nt
s_waitcnt lgkmcnt(0)
v_fma_f32 v20, v246, s67, -v17
v_fma_f32 v21, v247, s67, -v17
v_fma_f32 v22, v248, s67, -v17
v_fma_f32 v23, v249, s67, -v17
v_exp_f32 v20, v20
v_exp_f32 v21, v21
v_exp_f32 v22, v22
v_exp_f32 v23, v23
v_add_f32 v18, v18, v20
v_cvt_pk_bf16_f32 v20, v20, v20
v_add_f32 v18, v18, v21
v_cvt_pk_bf16_f32 v21, v21, v21
v_add_f32 v18, v18, v22
v_cvt_pk_bf16_f32 v22, v22, v22
v_add_f32 v18, v18, v23
v_cvt_pk_bf16_f32 v23, v23, v23
v_and_b32 v24, v20, v4
v_and_b32 v25, v20, v5
v_and_b32 v26, v20, v6
v_and_b32 v27, v20, v7
v_and_b32 v28, v21, v4
v_and_b32 v29, v21, v5
v_and_b32 v30, v21, v6
v_and_b32 v31, v21, v7
v_and_b32 v32, v22, v4
v_and_b32 v33, v22, v5
v_and_b32 v34, v22, v6
v_and_b32 v35, v22, v7
v_and_b32 v36, v23, v4
v_and_b32 v37, v23, v5
v_and_b32 v38, v23, v6
v_and_b32 v39, v23, v7
s_waitcnt vmcnt(28)
s_nop 0
v_mfma_f32_16x16x32_bf16 v[12:15], v[24:27], v[208:211], v[12:15]
v_mfma_f32_16x16x32_bf16 v[12:15], v[28:31], v[212:215], v[12:15]
v_mfma_f32_16x16x32_bf16 v[12:15], v[32:35], v[216:219], v[12:15]
v_mfma_f32_16x16x32_bf16 v[12:15], v[36:39], v[220:223], v[12:15]
s_waitcnt vmcnt(4)
buffer_load_dwordx4 v[208:211], v232, s[36:39], s61 offen nt
s_waitcnt vmcnt(4)
buffer_load_dwordx4 v[212:215], v233, s[36:39], s61 offen nt
s_waitcnt vmcnt(4)
buffer_load_dwordx4 v[216:219], v234, s[36:39], s61 offen nt
s_waitcnt vmcnt(5)
buffer_load_dwordx4 v[220:223], v235, s[36:39], s61 offen nt
s_add_u32 s61, s61, s76
s_waitcnt vmcnt(16)
v_readfirstlane_b32 s77, v224
L_dloop_8:
s_cmp_lt_u32 s77, 64
s_cselect_b32 s34, 0x1000000, 0
s_cselect_b32 s65, s80, 2
s_mov_b32 s38, s34
s_min_u32 s80, s80, s65
s_cmp_eq_u32 s80, 0
s_cbranch_scc1 L_flush_7
s_sub_u32 s80, s80, 1
s_lshr_b32 s65, s77, 4
s_and_b32 s65, s65, 31
s_lshl_b32 s65, s65, 15
s_add_u32 s61, s65, s89
s_and_b32 s65, s77, 15
s_lshl_b32 s65, s65, 20
s_add_u32 s61, s61, s65
v_mov_b32 v224, 1
s_mov_b64 exec, 1
buffer_atomic_add v224, v225, s[40:43], s81 offen sc0 sc1
s_mov_b64 exec, -1
s_waitcnt vmcnt(28)
v_mfma_f32_16x16x32_bf16 v[8:11], v[96:99], v[40:43], 0
v_mfma_f32_16x16x32_bf16 v[8:11], v[100:103], v[44:47], v[8:11]
v_mfma_f32_16x16x32_bf16 v[8:11], v[104:107], v[48:51], v[8:11]
v_mfma_f32_16x16x32_bf16 v[8:11], v[108:111], v[52:55], v[8:11]
buffer_load_dwordx4 v[96:99], v228, s[32:35], s61 offen nt
buffer_load_dwordx4 v[100:103], v229, s[32:35], s61 offen nt
buffer_load_dwordx4 v[104:107], v230, s[32:35], s61 offen nt
buffer_load_dwordx4 v[108:111], v231, s[32:35], s61 offen nt
s_nop 3
v_cvt_pk_bf16_f32 v36, v8, v9
v_cvt_pk_bf16_f32 v37, v10, v11
v_lshlrev_b32 v8, 16, v36
v_and_b32 v9, s69, v36
v_lshlrev_b32 v10, 16, v37
v_and_b32 v11, s69, v37
v_mul_f32 v8, s62, v8
v_mul_f32 v9, s62, v9
v_mul_f32 v10, s62, v10
v_mul_f32 v11, s62, v11
v_cvt_pk_bf16_f32 v36, v8, v9
v_cvt_pk_bf16_f32 v37, v10, v11
v_lshlrev_b32 v8, 16, v36
v_and_b32 v9, s69, v36
v_lshlrev_b32 v10, 16, v37
v_and_b32 v11, s69, v37
v_max3_f32 v19, v8, v9, v10
v_max_f32 v19, v19, v11
v_cmp_gt_f32 vcc, v19, v16
s_cbranch_vccnz L_rare_21
L_back_22:
v_fma_f32 v20, v8, s67, -v17
v_fma_f32 v21, v9, s67, -v17
v_fma_f32 v22, v10, s67, -v17
v_fma_f32 v23, v11, s67, -v17
v_exp_f32 v20, v20
v_exp_f32 v21, v21
v_exp_f32 v22, v22
v_exp_f32 v23, v23
v_add_f32 v18, v18, v20
v_cvt_pk_bf16_f32 v20, v20, v20
v_add_f32 v18, v18, v21
v_cvt_pk_bf16_f32 v21, v21, v21
v_add_f32 v18, v18, v22
v_cvt_pk_bf16_f32 v22, v22, v22
v_add_f32 v18, v18, v23
v_cvt_pk_bf16_f32 v23, v23, v23
v_and_b32 v24, v20, v4
v_and_b32 v25, v20, v5
v_and_b32 v26, v20, v6
v_and_b32 v27, v20, v7
v_and_b32 v28, v21, v4
v_and_b32 v29, v21, v5
v_and_b32 v30, v21, v6
v_and_b32 v31, v21, v7
v_and_b32 v32, v22, v4
v_and_b32 v33, v22, v5
v_and_b32 v34, v22, v6
v_and_b32 v35, v22, v7
v_and_b32 v36, v23, v4
v_and_b32 v37, v23, v5
v_and_b32 v38, v23, v6
v_and_b32 v39, v23, v7
s_waitcnt vmcnt(28)
s_nop 0
v_mfma_f32_16x16x32_bf16 v[12:15], v[24:27], v[112:115], v[12:15]
v_mfma_f32_16x16x32_bf16 v[12:15], v[28:31], v[116:119], v[12:15]
v_mfma_f32_16x16x32_bf16 v[12:15], v[32:35], v[120:123], v[12:15]
v_mfma_f32_16x16x32_bf16 v[12:15], v[36:39], v[124:127], v[12:15]
buffer_load_dwordx4 v[112:115], v232, s[36:39], s61 offen nt
buffer_load_dwordx4 v[116:119], v233, s[36:39], s61 offen nt
buffer_load_dwordx4 v[120:123], v234, s[36:39], s61 offen nt
buffer_load_dwordx4 v[124:127], v235, s[36:39], s61 offen nt
s_add_u32 s61, s61, s76
s_waitcnt vmcnt(28)
v_mfma_f32_16x16x32_bf16 v[8:11], v[128:131], v[40:43], 0
v_mfma_f32_16x16x32_bf16 v[8:11], v[132:135], v[44:47], v[8:11]
v_mfma_f32_16x16x32_bf16 v[8:11], v[136:139], v[48:51], v[8:11]
v_mfma_f32_16x16x32_bf16 v[8:11], v[140:143], v[52:55], v[8:11]
buffer_load_dwordx4 v[128:131], v228, s[32:35], s61 offen nt
buffer_load_dwordx4 v[132:135], v229, s[32:35], s61 offen nt
buffer_load_dwordx4 v[136:139], v230, s[32:35], s61 offen nt
buffer_load_dwordx4 v[140:143], v231, s[32:35], s61 offen nt
s_nop 3
v_cvt_pk_bf16_f32 v36, v8, v9
v_cvt_pk_bf16_f32 v37, v10, v11
v_lshlrev_b32 v8, 16, v36
v_and_b32 v9, s69, v36
v_lshlrev_b32 v10, 16, v37
v_and_b32 v11, s69, v37
v_mul_f32 v8, s62, v8
v_mul_f32 v9, s62, v9
v_mul_f32 v10, s62, v10
v_mul_f32 v11, s62, v11
v_cvt_pk_bf16_f32 v36, v8, v9
v_cvt_pk_bf16_f32 v37, v10, v11
v_lshlrev_b32 v8, 16, v36
v_and_b32 v9, s69, v36
v_lshlrev_b32 v10, 16, v37
v_and_b32 v11, s69, v37
v_max3_f32 v19, v8, v9, v10
v_max_f32 v19, v19, v11
v_cmp_gt_f32 vcc, v19, v16
s_cbranch_vccnz L_rare_23
L_back_24:
v_fma_f32 v20, v8, s67, -v17
v_fma_f32 v21, v9, s67, -v17
v_fma_f32 v22, v10, s67, -v17
v_fma_f32 v23, v11, s67, -v17
v_exp_f32 v20, v20
v_exp_f32 v21, v21
v_exp_f32 v22, v22
v_exp_f32 v23, v23
v_add_f32 v18, v18, v20
v_cvt_pk_bf16_f32 v20, v20, v20
v_add_f32 v18, v18, v21
v_cvt_pk_bf16_f32 v21, v21, v21
v_add_f32 v18, v18, v22
v_cvt_pk_bf16_f32 v22, v22, v22
v_add_f32 v18, v18, v23
v_cvt_pk_bf16_f32 v23, v23, v23
v_and_b32 v24, v20, v4
v_and_b32 v25, v20, v5
v_and_b32 v26, v20, v6
v_and_b32 v27, v20, v7
v_and_b32 v28, v21, v4
v_and_b32 v29, v21, v5
v_and_b32 v30, v21, v6
v_and_b32 v31, v21, v7
v_and_b32 v32, v22, v4
v_and_b32 v33, v22, v5
v_and_b32 v34, v22, v6
v_and_b32 v35, v22, v7
v_and_b32 v36, v23, v4
v_and_b32 v37, v23, v5
v_and_b32 v38, v23, v6
v_and_b32 v39, v23, v7
s_waitcnt vmcnt(28)
s_nop 0
v_mfma_f32_16x16x32_bf16 v[12:15], v[24:27], v[144:147], v[12:15]
v_mfma_f32_16x16x32_bf16 v[12:15], v[28:31], v[148:151], v[12:15]
v_mfma_f32_16x16x32_bf16 v[12:15], v[32:35], v[152:155], v[12:15]
v_mfma_f32_16x16x32_bf16 v[12:15], v[36:39], v[156:159], v[12:15]
buffer_load_dwordx4 v[144:147], v232, s[36:39], s61 offen nt
buffer_load_dwordx4 v[148:151], v233, s[36:39], s61 offen nt
buffer_load_dwordx4 v[152:155], v234, s[36:39], s61 offen nt
buffer_load_dwordx4 v[156:159], v235, s[36:39], s61 offen nt
s_add_u32 s61, s61, s76
s_waitcnt vmcnt(16)
v_readfirstlane_b32 s77, v224
s_cmp_lt_u32 s77, 64
s_cselect_b32 s34, 0x1000000, 0
s_cselect_b32 s65, s80, 2
s_mov_b32 s38, s34
s_min_u32 s80, s80, s65
s_cmp_eq_u32 s80, 0
s_cbranch_scc1 L_flush_7
s_sub_u32 s80, s80, 1
s_lshr_b32 s65, s77, 4
s_and_b32 s65, s65, 31
s_lshl_b32 s65, s65, 15
s_add_u32 s61, s65, s89
s_and_b32 s65, s77, 15
s_lshl_b32 s65, s65, 20
s_add_u32 s61, s61, s65
v_mov_b32 v224, 1
s_mov_b64 exec, 1
buffer_atomic_add v224, v225, s[40:43], s81 offen sc0 sc1
s_mov_b64 exec, -1
s_waitcnt vmcnt(28)
v_mfma_f32_16x16x32_bf16 v[8:11], v[160:163], v[40:43], 0
v_mfma_f32_16x16x32_bf16 v[8:11], v[164:167], v[44:47], v[8:11]
v_mfma_f32_16x16x32_bf16 v[8:11], v[168:171], v[48:51], v[8:11]
v_mfma_f32_16x16x32_bf16 v[8:11], v[172:175], v[52:55], v[8:11]
buffer_load_dwordx4 v[160:163], v228, s[32:35], s61 offen nt
buffer_load_dwordx4 v[164:167], v229, s[32:35], s61 offen nt
buffer_load_dwordx4 v[168:171], v230, s[32:35], s61 offen nt
buffer_load_dwordx4 v[172:175], v231, s[32:35], s61 offen nt
s_nop 3
v_cvt_pk_bf16_f32 v36, v8, v9
v_cvt_pk_bf16_f32 v37, v10, v11
v_lshlrev_b32 v8, 16, v36
v_and_b32 v9, s69, v36
v_lshlrev_b32 v10, 16, v37
v_and_b32 v11, s69, v37
v_mul_f32 v8, s62, v8
v_mul_f32 v9, s62, v9
v_mul_f32 v10, s62, v10
v_mul_f32 v11, s62, v11
v_cvt_pk_bf16_f32 v36, v8, v9
v_cvt_pk_bf16_f32 v37, v10, v11
v_lshlrev_b32 v8, 16, v36
v_and_b32 v9, s69, v36
v_lshlrev_b32 v10, 16, v37
v_and_b32 v11, s69, v37
v_max3_f32 v19, v8, v9, v10
v_max_f32 v19, v19, v11
v_cmp_gt_f32 vcc, v19, v16
s_cbranch_vccnz L_rare_25
L_back_26:
v_fma_f32 v20, v8, s67, -v17
v_fma_f32 v21, v9, s67, -v17
v_fma_f32 v22, v10, s67, -v17
v_fma_f32 v23, v11, s67, -v17
v_exp_f32 v20, v20
v_exp_f32 v21, v21
v_exp_f32 v22, v22
v_exp_f32 v23, v23
v_add_f32 v18, v18, v20
v_cvt_pk_bf16_f32 v20, v20, v20
v_add_f32 v18, v18, v21
v_cvt_pk_bf16_f32 v21, v21, v21
v_add_f32 v18, v18, v22
v_cvt_pk_bf16_f32 v22, v22, v22
v_add_f32 v18, v18, v23
v_cvt_pk_bf16_f32 v23, v23, v23
v_and_b32 v24, v20, v4
v_and_b32 v25, v20, v5
v_and_b32 v26, v20, v6
v_and_b32 v27, v20, v7
v_and_b32 v28, v21, v4
v_and_b32 v29, v21, v5
v_and_b32 v30, v21, v6
v_and_b32 v31, v21, v7
v_and_b32 v32, v22, v4
v_and_b32 v33, v22, v5
v_and_b32 v34, v22, v6
v_and_b32 v35, v22, v7
v_and_b32 v36, v23, v4
v_and_b32 v37, v23, v5
v_and_b32 v38, v23, v6
v_and_b32 v39, v23, v7
s_waitcnt vmcnt(28)
s_nop 0
v_mfma_f32_16x16x32_bf16 v[12:15], v[24:27], v[176:179], v[12:15]
v_mfma_f32_16x16x32_bf16 v[12:15], v[28:31], v[180:183], v[12:15]
v_mfma_f32_16x16x32_bf16 v[12:15], v[32:35], v[184:187], v[12:15]
v_mfma_f32_16x16x32_bf16 v[12:15], v[36:39], v[188:191], v[12:15]
buffer_load_dwordx4 v[176:179], v232, s[36:39], s61 offen nt
buffer_load_dwordx4 v[180:183], v233, s[36:39], s61 offen nt
buffer_load_dwordx4 v[184:187], v234, s[36:39], s61 offen nt
buffer_load_dwordx4 v[188:191], v235, s[36:39], s61 offen nt
s_add_u32 s61, s61, s76
s_waitcnt vmcnt(28)
v_mfma_f32_16x16x32_bf16 v[8:11], v[192:195], v[40:43], 0
v_mfma_f32_16x16x32_bf16 v[8:11], v[196:199], v[44:47], v[8:11]
v_mfma_f32_16x16x32_bf16 v[8:11], v[200:203], v[48:51], v[8:11]
v_mfma_f32_16x16x32_bf16 v[8:11], v[204:207], v[52:55], v[8:11]
buffer_load_dwordx4 v[192:195], v228, s[32:35], s61 offen nt
buffer_load_dwordx4 v[196:199], v229, s[32:35], s61 offen nt
buffer_load_dwordx4 v[200:203], v230, s[32:35], s61 offen nt
buffer_load_dwordx4 v[204:207], v231, s[32:35], s61 offen nt
s_nop 3
v_cvt_pk_bf16_f32 v36, v8, v9
v_cvt_pk_bf16_f32 v37, v10, v11
v_lshlrev_b32 v8, 16, v36
v_and_b32 v9, s69, v36
v_lshlrev_b32 v10, 16, v37
v_and_b32 v11, s69, v37
v_mul_f32 v8, s62, v8
v_mul_f32 v9, s62, v9
v_mul_f32 v10, s62, v10
v_mul_f32 v11, s62, v11
v_cvt_pk_bf16_f32 v36, v8, v9
v_cvt_pk_bf16_f32 v37, v10, v11
v_lshlrev_b32 v8, 16, v36
v_and_b32 v9, s69, v36
v_lshlrev_b32 v10, 16, v37
v_and_b32 v11, s69, v37
v_max3_f32 v19, v8, v9, v10
v_max_f32 v19, v19, v11
v_cmp_gt_f32 vcc, v19, v16
s_cbranch_vccnz L_rare_27
L_back_28:
v_fma_f32 v20, v8, s67, -v17
v_fma_f32 v21, v9, s67, -v17
v_fma_f32 v22, v10, s67, -v17
v_fma_f32 v23, v11, s67, -v17
v_exp_f32 v20, v20
v_exp_f32 v21, v21
v_exp_f32 v22, v22
v_exp_f32 v23, v23
v_add_f32 v18, v18, v20
v_cvt_pk_bf16_f32 v20, v20, v20
v_add_f32 v18, v18, v21
v_cvt_pk_bf16_f32 v21, v21, v21
v_add_f32 v18, v18, v22
v_cvt_pk_bf16_f32 v22, v22, v22
v_add_f32 v18, v18, v23
v_cvt_pk_bf16_f32 v23, v23, v23
v_and_b32 v24, v20, v4
v_and_b32 v25, v20, v5
v_and_b32 v26, v20, v6
v_and_b32 v27, v20, v7
v_and_b32 v28, v21, v4
v_and_b32 v29, v21, v5
v_and_b32 v30, v21, v6
v_and_b32 v31, v21, v7
v_and_b32 v32, v22, v4
v_and_b32 v33, v22, v5
v_and_b32 v34, v22, v6
v_and_b32 v35, v22, v7
v_and_b32 v36, v23, v4
v_and_b32 v37, v23, v5
v_and_b32 v38, v23, v6
v_and_b32 v39, v23, v7
s_waitcnt vmcnt(28)
s_nop 0
v_mfma_f32_16x16x32_bf16 v[12:15], v[24:27], v[208:211], v[12:15]
v_mfma_f32_16x16x32_bf16 v[12:15], v[28:31], v[212:215], v[12:15]
v_mfma_f32_16x16x32_bf16 v[12:15], v[32:35], v[216:219], v[12:15]
v_mfma_f32_16x16x32_bf16 v[12:15], v[36:39], v[220:223], v[12:15]
buffer_load_dwordx4 v[208:211], v232, s[36:39], s61 offen nt
buffer_load_dwordx4 v[212:215], v233, s[36:39], s61 offen nt
buffer_load_dwordx4 v[216:219], v234, s[36:39], s61 offen nt
buffer_load_dwordx4 v[220:223], v235, s[36:39], s61 offen nt
s_add_u32 s61, s61, s76
s_waitcnt vmcnt(16)
v_readfirstlane_b32 s77, v224
s_branch L_dloop_8
L_rare_21:
v_max_f32 v19, v19, v16
v_mov_b32 v24, v19
s_nop 1
v_permlane32_swap_b32 v19, v24
v_max_f32 v19, v19, v24
v_mov_b32 v24, v19
s_nop 1
v_permlane16_swap_b32 v19, v24
v_max_f32 v16, v19, v24
v_mul_f32 v24, s67, v16
v_sub_f32 v25, v17, v24
v_exp_f32 v25, v25
v_mov_b32 v17, v24
s_nop 0
v_mul_f32 v18, v18, v25
v_mov_b32_dpp v26, v25 row_newbcast:0 row_mask:0x3 bank_mask:0xf
v_mov_b32_dpp v26, v25 row_newbcast:8 row_mask:0xc bank_mask:0xf
v_mul_f32 v12, v12, v26
v_mul_f32 v13, v13, v26
v_mul_f32 v14, v14, v26
v_mul_f32 v15, v15, v26
s_branch L_back_22
L_rare_23:
v_max_f32 v19, v19, v16
v_mov_b32 v24, v19
s_nop 1
v_permlane32_swap_b32 v19, v24
v_max_f32 v19, v19, v24
v_mov_b32 v24, v19
s_nop 1
v_permlane16_swap_b32 v19, v24
v_max_f32 v16, v19, v24
v_mul_f32 v24, s67, v16
v_sub_f32 v25, v17, v24
v_exp_f32 v25, v25
v_mov_b32 v17, v24
s_nop 0
v_mul_f32 v18, v18, v25
v_mov_b32_dpp v26, v25 row_newbcast:0 row_mask:0x3 bank_mask:0xf
v_mov_b32_dpp v26, v25 row_newbcast:8 row_mask:0xc bank_mask:0xf
v_mul_f32 v12, v12, v26
v_mul_f32 v13, v13, v26
v_mul_f32 v14, v14, v26
v_mul_f32 v15, v15, v26
s_branch L_back_24
L_rare_25:
v_max_f32 v19, v19, v16
v_mov_b32 v24, v19
s_nop 1
v_permlane32_swap_b32 v19, v24
v_max_f32 v19, v19, v24
v_mov_b32 v24, v19
s_nop 1
v_permlane16_swap_b32 v19, v24
v_max_f32 v16, v19, v24
v_mul_f32 v24, s67, v16
v_sub_f32 v25, v17, v24
v_exp_f32 v25, v25
v_mov_b32 v17, v24
s_nop 0
v_mul_f32 v18, v18, v25
v_mov_b32_dpp v26, v25 row_newbcast:0 row_mask:0x3 bank_mask:0xf
v_mov_b32_dpp v26, v25 row_newbcast:8 row_mask:0xc bank_mask:0xf
v_mul_f32 v12, v12, v26
v_mul_f32 v13, v13, v26
v_mul_f32 v14, v14, v26
v_mul_f32 v15, v15, v26
s_branch L_back_26
L_rare_27:
v_max_f32 v19, v19, v16
v_mov_b32 v24, v19
s_nop 1
v_permlane32_swap_b32 v19, v24
v_max_f32 v19, v19, v24
v_mov_b32 v24, v19
s_nop 1
v_permlane16_swap_b32 v19, v24
v_max_f32 v16, v19, v24
v_mul_f32 v24, s67, v16
v_sub_f32 v25, v17, v24
v_exp_f32 v25, v25
v_mov_b32 v17, v24
s_nop 0
v_mul_f32 v18, v18, v25
v_mov_b32_dpp v26, v25 row_newbcast:0 row_mask:0x3 bank_mask:0xf
v_mov_b32_dpp v26, v25 row_newbcast:8 row_mask:0xc bank_mask:0xf
v_mul_f32 v12, v12, v26
v_mul_f32 v13, v13, v26
v_mul_f32 v14, v14, v26
v_mul_f32 v15, v15, v26
s_branch L_back_28
L_flush_7:
v_mov_b32 v19, v18
s_nop 1
v_permlane32_swap_b32 v18, v19
v_add_f32 v18, v18, v19
v_mov_b32 v19, v18
s_nop 1
v_permlane16_swap_b32 v18, v19
v_add_f32 v18, v18, v19
s_mul_i32 s65, s30, 1040
s_add_u32 s65, s65, 8320
v_lshrrev_b32 v19, 5, v0
v_lshlrev_b32 v19, 9, v19
v_and_b32 v20, 15, v0
v_lshl_add_u32 v19, v20, 5, v19
v_bfe_u32 v20, v0, 4, 1
v_lshl_add_u32 v19, v20, 4, v19
v_add_u32 v19, s65, v19
v_bfe_u32 v20, v0, 3, 1
v_lshl_add_u32 v20, v20, 3, s65
v_mov_b32 v22, v17
v_mov_b32 v23, v18
ds_write_b128 v19, v[12:15] offset:3072
ds_write_b64 v20, v[22:23] offset:4096
s_waitcnt lgkmcnt(0)
s_cbranch_execz L_skip_35
s_barrier
L_skip_35:
s_sub_u32 s65, s30, 1
s_max_i32 s65, s65, 0
s_mul_i32 s65, s65, 4160
s_cmp_eq_u32 s30, 1
s_cselect_b32 s66, 512, 0
s_cselect_b32 s68, 8, 0
s_add_u32 s66, s66, s65
s_add_u32 s68, s68, s65
v_lshl_add_u32 v19, v0, 3, s66
v_mov_b32 v20, s68
ds_read_b64 v[24:25], v19 offset:3072
ds_read_b64 v[32:33], v20 offset:4096
ds_read_b64 v[26:27], v19 offset:4112
ds_read_b64 v[34:35], v20 offset:5136
ds_read_b64 v[28:29], v19 offset:5152
ds_read_b64 v[36:37], v20 offset:6176
ds_read_b64 v[30:31], v19 offset:6192
ds_read_b64 v[38:39], v20 offset:7216
s_lshl_b32 s65, s31, 2
s_add_u32 s65, s65, s30
s_lshl_b32 s65, s65, 4
s_add_u32 s65, s65, s64
s_lshl_b32 s66, s65, 10
s_add_u32 s66, s66, 65536
s_lshl_b32 s65, s65, 4
s_add_u32 s65, s65, 1114112
v_lshlrev_b32 v19, 4, v0
v_mov_b32 v20, 0
v_mov_b32 v13, s73
v_mov_b32 v15, s73
v_mov_b32 v9, s73
v_mov_b32 v11, s73
s_waitcnt lgkmcnt(0)
v_max3_f32 v8, v32, v34, v36
v_max_f32 v8, v8, v38
v_sub_f32 v32, v32, v8
v_sub_f32 v34, v34, v8
v_sub_f32 v36, v36, v8
v_sub_f32 v38, v38, v8
v_exp_f32 v32, v32
v_exp_f32 v34, v34
v_exp_f32 v36, v36
v_exp_f32 v38, v38
s_nop 0
v_mul_f32 v12, v32, v24
v_mul_f32 v14, v32, v25
v_mul_f32 v10, v32, v33
v_fmac_f32 v12, v34, v26
v_fmac_f32 v14, v34, v27
v_fmac_f32 v10, v34, v35
v_fmac_f32 v12, v36, v28
v_fmac_f32 v14, v36, v29
v_fmac_f32 v10, v36, v37
v_fmac_f32 v12, v38, v30
v_fmac_f32 v14, v38, v31
v_fmac_f32 v10, v38, v39
s_cbranch_execz L_skip_36
buffer_store_dwordx4 v[12:15], v19, s[40:43], s66 offen sc1
L_skip_36:
s_and_b64 exec, s[82:83], 1
s_cbranch_execz L_skip_37
buffer_store_dwordx4 v[8:11], v20, s[40:43], s65 offen sc1
L_skip_37:
s_and_b64 exec, s[82:83], -1
s_lshr_b32 s65, s64, 2
s_lshl_b32 s66, s31, 2
s_add_u32 s65, s65, s66
s_lshl_b32 s66, s65, 14
s_and_b32 s68, s64, 3
s_lshl_b32 s68, s68, 8
s_add_u32 s66, s66, s68
s_lshl_b32 s68, s30, 6
s_add_u32 s66, s66, s68
s_add_u32 s66, s66, 65536
s_lshl_b32 s65, s65, 8
s_add_u32 s65, s65, 1114112
v_and_b32 v19, 15, v0
v_lshlrev_b32 v20, 4, v19
v_lshlrev_b32 v19, 10, v19
v_lshrrev_b32 v21, 4, v0
v_lshl_add_u32 v19, v21, 4, v19
s_mov_b32 s72, 0x200000
L_poll_29:
s_cbranch_execz L_skip_38
buffer_load_dwordx4 v[24:27], v20, s[40:43], s65 offen sc1
buffer_load_dwordx4 v[28:31], v19, s[40:43], s66 offen sc1
L_skip_38:
s_waitcnt vmcnt(0)
v_xor_b32 v32, s73, v25
v_xor_b32 v33, s73, v27
v_or_b32 v32, v32, v33
v_xor_b32 v33, s73, v29
v_or_b32 v32, v32, v33
v_xor_b32 v33, s73, v31
v_or_b32 v32, v32, v33
v_cmp_ne_u32 vcc, 0, v32
s_cbranch_vccz L_pollx_30
s_sub_u32 s72, s72, 1
s_cmp_lg_u32 s72, 0
s_cbranch_scc1 L_poll_29
L_pollx_30:
v_mov_b32 v21, v24
s_nop 1
v_max_f32_dpp v21, v21, v21 row_ror:8 row_mask:0xf bank_mask:0xf
s_nop 1
v_max_f32_dpp v21, v21, v21 row_ror:4 row_mask:0xf bank_mask:0xf
s_nop 1
v_max_f32_dpp v21, v21, v21 row_ror:2 row_mask:0xf bank_mask:0xf
s_nop 1
v_max_f32_dpp v21, v21, v21 row_ror:1 row_mask:0xf bank_mask:0xf
v_sub_f32 v24, v24, v21
v_exp_f32 v24, v24
s_nop 0
v_mul_f32 v26, v26, v24
v_mul_f32 v28, v28, v24
v_mul_f32 v30, v30, v24
s_nop 1
v_add_f32_dpp v26, v26, v26 row_ror:8 row_mask:0xf bank_mask:0xf
v_add_f32_dpp v28, v28, v28 row_ror:8 row_mask:0xf bank_mask:0xf
v_add_f32_dpp v30, v30, v30 row_ror:8 row_mask:0xf bank_mask:0xf
s_nop 1
v_add_f32_dpp v26, v26, v26 row_ror:4 row_mask:0xf bank_mask:0xf
v_add_f32_dpp v28, v28, v28 row_ror:4 row_mask:0xf bank_mask:0xf
v_add_f32_dpp v30, v30, v30 row_ror:4 row_mask:0xf bank_mask:0xf
s_nop 1
v_add_f32_dpp v26, v26, v26 row_ror:2 row_mask:0xf bank_mask:0xf
v_add_f32_dpp v28, v28, v28 row_ror:2 row_mask:0xf bank_mask:0xf
v_add_f32_dpp v30, v30, v30 row_ror:2 row_mask:0xf bank_mask:0xf
s_nop 1
v_add_f32_dpp v26, v26, v26 row_ror:1 row_mask:0xf bank_mask:0xf
v_add_f32_dpp v28, v28, v28 row_ror:1 row_mask:0xf bank_mask:0xf
v_add_f32_dpp v30, v30, v30 row_ror:1 row_mask:0xf bank_mask:0xf
v_rcp_f32 v26, v26
s_nop 0
v_mul_f32 v28, v28, v26
v_mul_f32 v30, v30, v26
v_cvt_pk_bf16_f32 v28, v28, v28
v_cvt_pk_bf16_f32 v30, v30, v30
v_and_b32 v32, v28, v4
v_and_b32 v33, v28, v5
v_and_b32 v34, v28, v6
v_and_b32 v35, v28, v7
v_and_b32 v36, v30, v4
v_and_b32 v37, v30, v5
v_and_b32 v38, v30, v6
v_and_b32 v39, v30, v7
s_nop 1
v_mfma_f32_16x16x32_bf16 v[100:103], v[32:35], v[56:59], 0
v_mfma_f32_16x16x32_bf16 v[104:107], v[32:35], v[60:63], 0
v_mfma_f32_16x16x32_bf16 v[108:111], v[32:35], v[64:67], 0
v_mfma_f32_16x16x32_bf16 v[112:115], v[32:35], v[68:71], 0
v_mfma_f32_16x16x32_bf16 v[116:119], v[32:35], v[72:75], 0
v_mfma_f32_16x16x32_bf16 v[100:103], v[36:39], v[76:79], v[100:103]
v_mfma_f32_16x16x32_bf16 v[104:107], v[36:39], v[80:83], v[104:107]
v_mfma_f32_16x16x32_bf16 v[108:111], v[36:39], v[84:87], v[108:111]
v_mfma_f32_16x16x32_bf16 v[112:115], v[36:39], v[88:91], v[112:115]
v_mfma_f32_16x16x32_bf16 v[116:119], v[36:39], v[92:95], v[116:119]
s_mul_i32 s65, s30, 2560
v_and_b32 v19, 15, v0
v_lshl_add_u32 v19, v19, 5, s65
v_bfe_u32 v20, v0, 4, 1
v_lshl_add_u32 v19, v20, 4, v19
s_nop 4
s_mov_b32 exec_hi, 0
ds_write_b128 v19, v[100:103] offset:16384
ds_write_b128 v19, v[104:107] offset:16896
ds_write_b128 v19, v[108:111] offset:17408
ds_write_b128 v19, v[112:115] offset:17920
ds_write_b128 v19, v[116:119] offset:18432
s_and_b64 exec, s[82:83], -1
s_cmp_lt_u32 s64, 8
s_cselect_b32 s69, 1, 0
s_mul_i32 s65, s69, 589824
s_and_b32 s66, s64, 7
s_lshl_b32 s68, s31, 3
s_add_u32 s66, s66, s68
s_lshl_b32 s66, s66, 6
s_add_u32 s65, s65, s66
s_add_u32 s65, s65, 2228224
v_lshlrev_b32 v19, 4, v3
v_lshrrev_b32 v20, 1, v3
v_lshlrev_b32 v20, 13, v20
v_and_b32 v21, 1, v3
v_lshl_add_u32 v20, v21, 5, v20
v_mov_b32 v41, s73
v_mov_b32 v43, s73
v_mov_b32 v45, s73
v_mov_b32 v47, s73
s_waitcnt lgkmcnt(0)
s_cbranch_execz L_skip_39
s_barrier
L_skip_39:
v_cmp_gt_u32 vcc, 144, v3
s_and_saveexec_b64 s[70:71], vcc
s_cmp_eq_u32 s82, 0
s_cbranch_scc1 L_fall_40
s_cbranch_execz L_noy_31
L_fall_40:
ds_read_b128 v[24:27], v19 offset:16384
ds_read_b128 v[28:31], v19 offset:18944
ds_read_b128 v[32:35], v19 offset:21504
ds_read_b128 v[36:39], v19 offset:24064
s_waitcnt lgkmcnt(0)
v_add_f32 v24, v24, v28
v_add_f32 v32, v32, v36
v_add_f32 v25, v25, v29
v_add_f32 v33, v33, v37
v_add_f32 v26, v26, v30
v_add_f32 v34, v34, v38
v_add_f32 v27, v27, v31
v_add_f32 v35, v35, v39
v_add_f32 v40, v24, v32
v_add_f32 v42, v25, v33
v_add_f32 v44, v26, v34
v_add_f32 v46, v27, v35
s_cbranch_execz L_skip_41
buffer_store_dwordx4 v[40:43], v20, s[40:43], s65 offen sc1
buffer_store_dwordx4 v[44:47], v20, s[40:43], s65 offen offset:16 sc1
L_skip_41:
L_noy_31:
s_mov_b64 exec, s[70:71]
s_cmp_ge_u32 s3, 144
s_cbranch_scc1 L_end_1
s_lshl_b32 s65, s3, 13
s_add_u32 s65, s65, 2228224
s_add_u32 s66, s65, 4096
v_lshlrev_b32 v19, 4, v3
s_mov_b32 s44, s24
s_mov_b32 s45, s25
s_mov_b32 s46, 2304
s_mov_b32 s47, 0x20000
s_lshl_b32 s68, s30, 5
v_and_b32 v21, 3, v0
v_lshl_add_u32 v21, v21, 3, s68
s_mov_b32 s72, 0x200000
L_poll_32:
s_cbranch_execz L_skip_42
buffer_load_dwordx4 v[24:27], v19, s[40:43], s65 offen sc1
buffer_load_dwordx4 v[28:31], v19, s[40:43], s66 offen sc1
L_skip_42:
s_waitcnt vmcnt(0)
v_xor_b32 v32, s73, v25
v_xor_b32 v33, s73, v27
v_or_b32 v32, v32, v33
v_xor_b32 v33, s73, v29
v_or_b32 v32, v32, v33
v_xor_b32 v33, s73, v31
v_or_b32 v32, v32, v33
v_cmp_ne_u32 vcc, 0, v32
s_cbranch_vccz L_pollx_33
s_sub_u32 s72, s72, 1
s_cmp_lg_u32 s72, 0
s_cbranch_scc1 L_poll_32
L_pollx_33:
v_add_f32 v24, v24, v28
v_add_f32 v25, v26, v30
s_nop 1
v_add_f32_dpp v24, v24, v24 row_ror:4 row_mask:0xf bank_mask:0xf
v_add_f32_dpp v25, v25, v25 row_ror:4 row_mask:0xf bank_mask:0xf
s_nop 1
v_add_f32_dpp v24, v24, v24 row_ror:8 row_mask:0xf bank_mask:0xf
v_add_f32_dpp v25, v25, v25 row_ror:8 row_mask:0xf bank_mask:0xf
v_mov_b32 v28, v24
v_mov_b32 v29, v25
s_nop 1
v_permlane32_swap_b32 v24, v28
v_permlane32_swap_b32 v25, v29
v_add_f32 v24, v24, v28
v_add_f32 v25, v25, v29
v_mov_b32 v28, v24
v_mov_b32 v29, v25
s_nop 1
v_permlane16_swap_b32 v24, v28
v_permlane16_swap_b32 v25, v29
v_add_f32 v24, v24, v28
v_add_f32 v25, v25, v29
s_and_b64 exec, s[82:83], 0xf
ds_write_b64 v21, v[24:25] offset:26624
s_and_b64 exec, s[82:83], -1
s_waitcnt lgkmcnt(0)
s_cbranch_execz L_skip_43
s_barrier
L_skip_43:
s_cmp_lg_u32 s30, 0
s_cbranch_scc1 L_end_1
s_cmp_lg_u32 s3, 0
s_cbranch_scc1 L_noep_34
s_and_b64 exec, s[82:83], 1
v_mov_b32 v21, 3407872
v_mov_b32 v20, s73
s_cbranch_execz L_skip_44
buffer_store_dword v20, v21, s[40:43], 0 offen
L_skip_44:
L_noep_34:
s_and_b64 exec, s[82:83], 0xff
v_lshlrev_b32 v19, 2, v0
ds_read_b32 v24, v19 offset:26624
ds_read_b32 v25, v19 offset:26656
ds_read_b32 v26, v19 offset:26688
ds_read_b32 v27, v19 offset:26720
s_lshl_b32 s65, s3, 4
v_lshlrev_b32 v19, 1, v0
s_waitcnt lgkmcnt(0)
v_add_f32 v24, v24, v25
v_add_f32 v26, v26, v27
v_add_f32 v24, v24, v26
v_cvt_pk_bf16_f32 v24, v24, v24
s_cbranch_execz L_skip_45
buffer_store_short v24, v19, s[44:47], s65 offen
L_skip_45:
s_endpgm
L_svc_2:
s_setprio 3
s_waitcnt lgkmcnt(0)
s_mov_b32 s40, s28
s_mov_b32 s41, s29
s_add_u32 s74, s28, 3407872
s_addc_u32 s75, s29, 0
s_load_dword s73, s[74:75], 0
s_cmp_lg_u32 s64, 0
s_cbranch_scc1 L_notlead_46
s_lshl_b32 s65, s31, 10
s_add_u32 s65, s65, 3411968
v_lshlrev_b32 v19, 8, v0
v_mov_b32 v20, 0
s_mov_b64 exec, 0xf
buffer_store_dword v20, v19, s[40:43], s65 offen sc1
s_mov_b64 exec, -1
L_notlead_46:
v_mov_b32 v228, 0
v_mov_b32 v229, 0
v_mov_b32 v230, 0
v_mov_b32 v231, 0
v_mov_b32 v232, 0
v_mov_b32 v233, 0
v_mov_b32 v234, 0
v_mov_b32 v235, 0
s_mov_b64 s[32:33], s[28:29]
s_mov_b32 s34, 0
s_mov_b32 s35, s43
s_mov_b64 s[36:37], s[28:29]
s_mov_b32 s38, 0
s_mov_b32 s39, s43
s_mov_b32 s61, 0
s_mov_b32 s76, 0
s_mov_b64 s[82:83], 0
s_mov_b64 exec, 0
s_branch L_qc_3
L_svc2_4:
s_mov_b64 exec, -1
s_waitcnt vmcnt(0) lgkmcnt(0)
s_add_u32 s73, s73, 0x9e3779b1
s_barrier
v_and_b32 v24, 31, v0
v_lshlrev_b32 v24, 2, v24
v_lshrrev_b32 v25, 5, v0
v_lshl_add_u32 v24, v25, 10, v24
ds_read_b32 v26, v24 offset:1024
ds_read_b32 v27, v24 offset:1152
ds_read_b32 v28, v24 offset:1280
ds_read_b32 v29, v24 offset:1408
ds_read_b32 v30, v24 offset:1536
ds_read_b32 v31, v24 offset:1664
ds_read_b32 v32, v24 offset:1792
ds_read_b32 v33, v24 offset:1920
s_and_b32 s65, s64, 7
s_lshl_b32 s65, s65, 1
s_lshr_b32 s66, s64, 3
s_add_u32 s65, s65, s66
s_lshl_b32 s66, s31, 4
s_add_u32 s65, s65, s66
s_lshl_b32 s65, s65, 7
v_and_b32 v24, 31, v0
v_lshlrev_b32 v24, 2, v24
s_waitcnt lgkmcnt(0)
v_add_f32 v26, v26, v27
v_add_f32 v28, v28, v29
v_add_f32 v30, v30, v31
v_add_f32 v32, v32, v33
v_add_f32 v26, v26, v28
v_add_f32 v30, v30, v32
v_add_f32 v26, v26, v30
v_mov_b32 v27, v26
s_nop 1
v_permlane32_swap_b32 v26, v27
v_add_f32 v26, v26, v27
s_nop 1
v_mov_b32_dpp v27, v26 quad_perm:[1,0,3,2] row_mask:0xf bank_mask:0xf
v_cvt_pk_bf16_f32 v26, v26, v27
v_mov_b32 v27, s73
s_mov_b32 exec_lo, 0x55555555
s_mov_b32 exec_hi, 0
buffer_store_dwordx2 v[26:27], v24, s[40:43], s65 offen sc1
s_mov_b64 exec, -1
s_lshl_b32 s65, s31, 11
v_lshlrev_b32 v19, 5, v0
v_lshlrev_b32 v21, 4, v0
s_mov_b32 exec_hi, 0
s_mov_b32 s72, 0x200000
L_poll_47:
buffer_load_dwordx4 v[24:27], v19, s[40:43], s65 offen sc1
buffer_load_dwordx4 v[28:31], v19, s[40:43], s65 offen offset:16 sc1
s_waitcnt vmcnt(0)
v_xor_b32 v32, s73, v25
v_xor_b32 v33, s73, v27
v_or_b32 v32, v32, v33
v_xor_b32 v33, s73, v29
v_or_b32 v32, v32, v33
v_xor_b32 v33, s73, v31
v_or_b32 v32, v32, v33
v_cmp_ne_u32 vcc, 0, v32
s_cbranch_vccz L_pollx_48
s_sub_u32 s72, s72, 1
s_cmp_lg_u32 s72, 0
s_cbranch_scc1 L_poll_47
L_pollx_48:
v_mov_b32 v25, v26
v_mov_b32 v26, v28
v_mov_b32 v27, v30
ds_write_b128 v21, v[24:27] offset:0
s_waitcnt lgkmcnt(0)
s_mov_b64 exec, -1
s_barrier
s_mov_b32 exec_lo, 0
s_mov_b32 exec_hi, -1
s_mov_b32 s72, 0x200000
L_poll_49:
buffer_load_dwordx4 v[24:27], v19, s[40:43], s65 offen sc1
buffer_load_dwordx4 v[28:31], v19, s[40:43], s65 offen offset:16 sc1
s_waitcnt vmcnt(0)
v_xor_b32 v32, s73, v25
v_xor_b32 v33, s73, v27
v_or_b32 v32, v32, v33
v_xor_b32 v33, s73, v29
v_or_b32 v32, v32, v33
v_xor_b32 v33, s73, v31
v_or_b32 v32, v32, v33
v_cmp_ne_u32 vcc, 0, v32
s_cbranch_vccz L_pollx_50
s_sub_u32 s72, s72, 1
s_cmp_lg_u32 s72, 0
s_cbranch_scc1 L_poll_49
L_pollx_50:
v_mov_b32 v25, v26
v_mov_b32 v26, v28
v_mov_b32 v27, v30
ds_write_b128 v21, v[24:27] offset:0
s_waitcnt lgkmcnt(0)
s_mov_b64 exec, -1
s_barrier
s_setprio 0
v_mov_b32 v19, 0
v_mov_b32 v20, 0
v_mov_b32 v21, 0
s_mov_b64 s[82:83], 0
s_mov_b64 exec, 0
s_mov_b32 s3, 0
s_mov_b32 s30, 0
s_branch L_flush_7
L_end_1:
s_endpgm
.section .rodata,"a"
.p2align 6
.amdhsa_kernel concat_heads__mha_block_cached__gqa_block_cached__decode_kernel
  .amdhsa_next_free_vgpr 251
  .amdhsa_next_free_sgpr 102
  .amdhsa_accum_offset 252
  .amdhsa_group_segment_fixed_size 0
  .amdhsa_kernarg_size 104
  .amdhsa_user_sgpr_count 2
  .amdhsa_user_sgpr_kernarg_segment_ptr 1
  .amdhsa_system_sgpr_workgroup_id_x 1
.end_amdhsa_kernel
```
